```python
import torch

def _softmax(x, axis=-1):
    return torch.softmax(x, dim=axis)
def _gelu(x):
    return torch.nn.functional.gelu(x, approximate="tanh")
def _silu(x):
    return torch.nn.functional.silu(x)
def _sigmoid(x):
    return torch.sigmoid(x)
def _layernorm(x, axis=-1, eps=1e-5):
    m = x.mean(dim=axis, keepdim=True)
    v = x.var(dim=axis, keepdim=True, unbiased=False)
    return (x - m) / torch.sqrt(v + eps)
def _scatter_add(tgt, idx, src, axis=0):
    return tgt.clone().index_add_(axis, idx, src)
def _segment_sum(src, seg, n):
    out = torch.zeros((n,) + src.shape[1:], dtype=src.dtype)
    return out.index_add_(0, seg, src)
def _pad(x, pw):
    flat = tuple(v for pair in reversed(pw) for v in pair)
    return torch.nn.functional.pad(x, flat)

kernel_name = 'standalone__paged_block_table_kv_radixattention__decode'

def setup_inputs():

    _w = (lambda a: (lambda t: t.to(torch.bfloat16) if t.is_floating_point() else t)(torch.as_tensor(a)))
    B, H, Hkv, Dh = 8, 32, 8, 128
    Lk = 8192
    bs = 16
    nb = max(2, Lk // bs)
    P = max(1, nb // 2)
    n_phys = P + B * (nb - P)
    shared = torch.arange(P, dtype=torch.int64)
    priv = P + torch.arange(B * (nb - P), dtype=torch.int64).reshape(B, nb - P)
    bt = torch.cat([torch.tile(shared[None, :], (B, 1)), priv], dim=1)
    ctx = nb * bs - (torch.arange(1, B + 1, dtype=torch.int64) * 2654435761) % max(1, (nb * bs - P * bs) // 2)
    return {
        "q": _w((lambda *s: torch.randn(*s, dtype=torch.bfloat16) * 0.8)(B, H, Dh)),
        "k_cache": _w((lambda *s: torch.randn(*s, dtype=torch.bfloat16) * 0.8)(n_phys, bs, Hkv, Dh)),
        "v_cache": _w((lambda *s: torch.randn(*s, dtype=torch.bfloat16) * 0.05)(n_phys, bs, Hkv, Dh)),
        "block_table": _w(bt.to(torch.int64)),
        "ctx_lens": _w(torch.as_tensor(ctx).to(torch.int64)),
    }

def reference(q, k_cache, v_cache, block_table, ctx_lens):
    B, H, Dh = q.shape
    n_phys, bs, Hkv, _ = k_cache.shape
    nb = block_table.shape[1]
    Lk = nb * bs
    rep = H // Hkv
    k = k_cache[block_table].reshape(B, Lk, Hkv, Dh)
    v = v_cache[block_table].reshape(B, Lk, Hkv, Dh)
    k = (lambda x, n, axis: torch.repeat_interleave(x, n, dim=axis))(k, rep, axis=2)
    v = (lambda x, n, axis: torch.repeat_interleave(x, n, dim=axis))(v, rep, axis=2)
    scores = torch.einsum("bhd,bkhd->bhk", q, k) * (Dh ** -0.5)
    pos = torch.arange(Lk)
    valid = pos[None, :] < ctx_lens[:, None]
    scores = torch.where(valid[:, None, :], scores, -1e9)
    p = _softmax(scores, axis=-1)
    return torch.einsum("bhk,bkhd->bhd", p, v)
```

```asm
; @launch grid=(256,1,1) block=(512,1,1) lds=161856
.amdgcn_target "amdgcn-amd-amdhsa--gfx950"
.text
.globl standalone__paged_block_table_kv_radixattention__decode_kernel
.p2align 8
.type standalone__paged_block_table_kv_radixattention__decode_kernel,@function
standalone__paged_block_table_kv_radixattention__decode_kernel:
    s_cmp_ge_u32 s2, 256
    s_cbranch_scc1 L_end2
    s_load_dwordx16 s[16:31], s[0:1], 0
    v_lshrrev_b32 v21, 6, v0
    v_and_b32 v1, 63, v0
    v_readfirstlane_b32 s3, v21
    s_and_b32 s4, s2, 7
    s_xor_b32 s4, s4, 1
    s_lshr_b32 s5, s2, 3
    s_and_b32 s79, s4, 3
    s_cmp_eq_u32 s79, 1
    s_cselect_b32 s11, 35, 31
    s_cmp_ge_u32 s5, s11
    s_cbranch_scc0 L_map2
    s_max_u32 s79, s79, 1
    s_add_u32 s5, s79, 31
    s_and_b32 s4, s4, 4
    s_or_b32 s4, s4, 1
    s_mov_b32 s11, 35
L_map2:
    v_and_b32 v52, 15, v1
    v_lshrrev_b32 v53, 4, v1
    v_lshlrev_b32 v30, 2, v0
    s_lshl_b32 s79, s4, 8
    s_mul_i32 s15, s3, 16896
    v_lshlrev_b32 v6, 13, v53
    v_lshl_add_u32 v6, v52, 4, v6
    v_add_u32 v6, s79, v6
    v_add_u32 v7, 0x1000, v6
    v_xor_b32 v54, v53, v52
    v_lshlrev_b32 v55, 11, v53
    v_add_u32 v55, s79, v55
    v_lshl_add_u32 v2, v54, 4, v55
    v_xor_b32 v56, 4, v54
    v_lshl_add_u32 v3, v56, 4, v55
    v_add_u32 v3, 7168, v3
    v_xor_b32 v56, 8, v54
    v_lshl_add_u32 v4, v56, 4, v55
    v_add_u32 v4, 14336, v4
    v_xor_b32 v56, 12, v54
    v_lshl_add_u32 v5, v56, 4, v55
    v_add_u32 v5, 21504, v5
    v_add_u32 v31, 0x1000, v30
    v_add_u32 v21, 0x2000, v30
    v_add_u32 v24, 0x3000, v30
    s_and_b32 s100, s3, 3
    s_lshl_b32 s100, s100, 2
    v_xor_b32 v57, s100, v54
    v_lshlrev_b32 v57, 4, v57
    v_lshl_add_u32 v57, v53, 8, v57
    s_lshl_b32 s94, s3, 13
    s_lshl_b32 s100, s4, 10
    s_add_u32 s94, s94, s100
    s_lshl_b32 s95, s3, 10
    s_add_u32 s95, s95, 153600
    s_mov_b32 s50, 16384
    s_mov_b32 s51, 0x00020000
    s_mov_b32 s54, 65536
    s_mov_b32 s55, 0x00020000
    s_mov_b32 s42, 75497472
    s_mov_b32 s43, 0x00020000
    s_mov_b32 s46, 75497472
    s_mov_b32 s47, 0x00020000
    s_cmp_eq_u32 s11, 35
    s_cselect_b32 s6, 6, 5
    s_mov_b32 s7, -436562
    s_cselect_b32 s7, -392944, s7
    s_mov_b32 s8, 3968748
    s_cselect_b32 s8, 3572225, s8
    s_min_u32 s6, s6, s5
    s_mul_i32 s6, s6, s7
    s_mul_i32 s8, s8, s5
    s_sub_i32 s79, s5, 32
    s_max_i32 s79, s79, 0
    s_mul_i32 s79, s79, -607278
    s_add_u32 s6, s6, s8
    s_add_u32 s79, s79, s6
    s_add_u32 s79, s79, 32768
    s_lshr_b32 s79, s79, 16
    s_add_u32 s79, s79, s3
    s_mov_b32 s100, 0
    s_cmp_ge_u32 s79, 485
    s_cselect_b32 s100, 27, s100
    s_cmp_ge_u32 s79, 687
    s_cselect_b32 s100, 81, s100
    s_cmp_ge_u32 s79, 862
    s_cselect_b32 s100, 162, s100
    s_cmp_ge_u32 s79, 1010
    s_cselect_b32 s100, 270, s100
    s_cmp_ge_u32 s79, 1259
    s_cselect_b32 s100, 277, s100
    s_cmp_ge_u32 s79, 1481
    s_cselect_b32 s100, 311, s100
    s_cmp_ge_u32 s79, 1676
    s_cselect_b32 s100, 372, s100
    s_add_u32 s100, s100, s79
    s_lshl_b32 s84, s100, 15
    s_mov_b32 m0, s95
    s_waitcnt lgkmcnt(0)
    s_mov_b32 s48, s22
    s_mov_b32 s49, s23
    s_load_dwordx8 s[32:39], s[24:25], 0
    buffer_load_dword v36, v30, s[48:51], 0 offen offset:0
    buffer_load_dword v37, v30, s[48:51], 0 offen offset:2048
    buffer_load_dword v38, v31, s[48:51], 0 offen offset:0
    buffer_load_dword v39, v31, s[48:51], 0 offen offset:2048
    buffer_load_dword v40, v21, s[48:51], 0 offen offset:0
    buffer_load_dword v41, v21, s[48:51], 0 offen offset:2048
    buffer_load_dword v42, v24, s[48:51], 0 offen offset:0
    buffer_load_dword v43, v24, s[48:51], 0 offen offset:2048
    s_mov_b32 s52, s16
    s_mov_b32 s53, s17
    s_mov_b32 s40, s18
    s_mov_b32 s41, s19
    buffer_load_dwordx4 v57, s[52:55], s94 offen lds
    s_mov_b32 s44, s20
    s_mov_b32 s45, s21
    s_barrier
    s_add_u32 m0, s15, 0
    s_nop 0
    buffer_load_dwordx4 v2, s[40:43], s84 offen offset:0 nt lds
    buffer_load_dwordx4 v3, s[40:43], s84 offen offset:1024 nt lds
    buffer_load_dwordx4 v4, s[40:43], s84 offen offset:2048 nt lds
    buffer_load_dwordx4 v5, s[40:43], s84 offen offset:3072 nt lds
    buffer_load_dwordx4 v[164:167], v6, s[44:47], s84 offen offset:0 nt
    buffer_load_dwordx4 v[168:171], v6, s[44:47], s84 offen offset:2048 nt
    buffer_load_dwordx4 v[172:175], v7, s[44:47], s84 offen offset:0 nt
    buffer_load_dwordx4 v[176:179], v7, s[44:47], s84 offen offset:2048 nt
    s_mov_b32 s14, 0x3e0293ee
    s_mov_b32 s77, 0x05040100
    s_mov_b32 s78, 0x07060302
    s_mov_b32 s82, 0x000F000F
    s_mov_b32 s83, 0x000F000F
    v_lshlrev_b32 v55, 8, v52
    v_add_u32 v55, s15, v55
    v_lshl_add_u32 v8, v54, 4, v55
    v_xor_b32 v56, 4, v54
    v_lshl_add_u32 v9, v56, 4, v55
    v_xor_b32 v56, 8, v54
    v_lshl_add_u32 v10, v56, 4, v55
    v_xor_b32 v56, 12, v54
    v_lshl_add_u32 v11, v56, 4, v55
    v_mov_b32 v16, 0xff800000
    v_mov_b32 v17, 0xf1800000
    v_mov_b32 v18, 0xf1800000
    v_mov_b32 v19, 0
    v_mov_b32 v20, 0
    v_mov_b32 v100, 0
    v_mov_b32 v101, 0
    v_mov_b32 v102, 0
    v_mov_b32 v103, 0
    v_mov_b32 v104, 0
    v_mov_b32 v105, 0
    v_mov_b32 v106, 0
    v_mov_b32 v107, 0
    v_mov_b32 v108, 0
    v_mov_b32 v109, 0
    v_mov_b32 v110, 0
    v_mov_b32 v111, 0
    v_mov_b32 v112, 0
    v_mov_b32 v113, 0
    v_mov_b32 v114, 0
    v_mov_b32 v115, 0
    v_mov_b32 v116, 0
    v_mov_b32 v117, 0
    v_mov_b32 v118, 0
    v_mov_b32 v119, 0
    v_mov_b32 v120, 0
    v_mov_b32 v121, 0
    v_mov_b32 v122, 0
    v_mov_b32 v123, 0
    v_mov_b32 v124, 0
    v_mov_b32 v125, 0
    v_mov_b32 v126, 0
    v_mov_b32 v127, 0
    v_mov_b32 v128, 0
    v_mov_b32 v129, 0
    v_mov_b32 v130, 0
    v_mov_b32 v131, 0
    v_mov_b32 v132, 0
    v_mov_b32 v133, 0
    v_mov_b32 v134, 0
    v_mov_b32 v135, 0
    v_mov_b32 v136, 0
    v_mov_b32 v137, 0
    v_mov_b32 v138, 0
    v_mov_b32 v139, 0
    v_mov_b32 v140, 0
    v_mov_b32 v141, 0
    v_mov_b32 v142, 0
    v_mov_b32 v143, 0
    v_mov_b32 v144, 0
    v_mov_b32 v145, 0
    v_mov_b32 v146, 0
    v_mov_b32 v147, 0
    v_mov_b32 v148, 0
    v_mov_b32 v149, 0
    v_mov_b32 v150, 0
    v_mov_b32 v151, 0
    v_mov_b32 v152, 0
    v_mov_b32 v153, 0
    v_mov_b32 v154, 0
    v_mov_b32 v155, 0
    v_mov_b32 v156, 0
    v_mov_b32 v157, 0
    v_mov_b32 v158, 0
    v_mov_b32 v159, 0
    v_mov_b32 v160, 0
    v_mov_b32 v161, 0
    v_mov_b32 v162, 0
    v_mov_b32 v163, 0
    v_add_u32 v30, 137216, v30
    s_waitcnt lgkmcnt(0)
    s_mov_b32 s10, 0
    s_mov_b32 s16, 0
    s_cmp_lt_i32 s32, 1
    s_cselect_b32 s32, 8192, s32
    s_cselect_b32 s79, 1, 0
    s_or_b32 s16, s16, s79
    s_min_i32 s32, s32, 8192
    s_add_u32 s65, s32, 15
    s_lshr_b32 s65, s65, 4
    s_max_u32 s10, s10, s65
    s_cmp_lt_i32 s33, 1
    s_cselect_b32 s33, 8192, s33
    s_cselect_b32 s79, 2, 0
    s_or_b32 s16, s16, s79
    s_min_i32 s33, s33, 8192
    s_add_u32 s66, s33, 15
    s_lshr_b32 s66, s66, 4
    s_max_u32 s10, s10, s66
    s_cmp_lt_i32 s34, 1
    s_cselect_b32 s34, 8192, s34
    s_cselect_b32 s79, 4, 0
    s_or_b32 s16, s16, s79
    s_min_i32 s34, s34, 8192
    s_add_u32 s67, s34, 15
    s_lshr_b32 s67, s67, 4
    s_max_u32 s10, s10, s67
    s_cmp_lt_i32 s35, 1
    s_cselect_b32 s35, 8192, s35
    s_cselect_b32 s79, 8, 0
    s_or_b32 s16, s16, s79
    s_min_i32 s35, s35, 8192
    s_add_u32 s68, s35, 15
    s_lshr_b32 s68, s68, 4
    s_max_u32 s10, s10, s68
    s_cmp_lt_i32 s36, 1
    s_cselect_b32 s36, 8192, s36
    s_cselect_b32 s79, 16, 0
    s_or_b32 s16, s16, s79
    s_min_i32 s36, s36, 8192
    s_add_u32 s69, s36, 15
    s_lshr_b32 s69, s69, 4
    s_max_u32 s10, s10, s69
    s_cmp_lt_i32 s37, 1
    s_cselect_b32 s37, 8192, s37
    s_cselect_b32 s79, 32, 0
    s_or_b32 s16, s16, s79
    s_min_i32 s37, s37, 8192
    s_add_u32 s70, s37, 15
    s_lshr_b32 s70, s70, 4
    s_max_u32 s10, s10, s70
    s_cmp_lt_i32 s38, 1
    s_cselect_b32 s38, 8192, s38
    s_cselect_b32 s79, 64, 0
    s_or_b32 s16, s16, s79
    s_min_i32 s38, s38, 8192
    s_add_u32 s71, s38, 15
    s_lshr_b32 s71, s71, 4
    s_max_u32 s10, s10, s71
    s_cmp_lt_i32 s39, 1
    s_cselect_b32 s39, 8192, s39
    s_cselect_b32 s79, 128, 0
    s_or_b32 s16, s16, s79
    s_min_i32 s39, s39, 8192
    s_add_u32 s72, s39, 15
    s_lshr_b32 s72, s72, 4
    s_max_u32 s10, s10, s72
    s_lshl_b64 exec, s[82:83], 0
    v_mov_b32 v14, s32
    v_mov_b32 v15, s36
    s_lshl_b64 exec, s[82:83], 4
    v_mov_b32 v14, s33
    v_mov_b32 v15, s37
    s_lshl_b64 exec, s[82:83], 8
    v_mov_b32 v14, s34
    v_mov_b32 v15, s38
    s_lshl_b64 exec, s[82:83], 12
    v_mov_b32 v14, s35
    v_mov_b32 v15, s39
    s_mov_b64 exec, -1
    v_lshlrev_b32 v55, 2, v53
    v_sub_u32 v14, v14, v55
    v_sub_u32 v15, v15, v55
    s_lshl_b32 s79, s3, 2
    s_add_u32 s79, s79, 161792
    v_mov_b32 v31, s79
    s_lshl_b32 s79, s3, 6
    s_waitcnt vmcnt(9)
    v_xor_b32 v45, v36, v37
    v_xor_b32 v46, v36, v38
    v_xor_b32 v47, v36, v39
    v_xor_b32 v48, v36, v40
    v_xor_b32 v49, v36, v41
    v_xor_b32 v50, v36, v42
    v_xor_b32 v51, v36, v43
    v_or3_b32 v45, v45, v46, v47
    v_or3_b32 v48, v48, v49, v50
    v_or3_b32 v45, v45, v48, v51
    v_cmp_ne_u32 vcc, 0, v45
    ds_write2st64_b32 v30, v36, v37 offset0:0 offset1:8
    ds_write2st64_b32 v30, v38, v39 offset0:16 offset1:24
    ds_write2st64_b32 v30, v40, v41 offset0:32 offset1:40
    ds_write2st64_b32 v30, v42, v43 offset0:48 offset1:56
    s_ff1_i32_b64 s9, vcc
    s_add_u32 s9, s9, s79
    s_cmp_eq_u64 vcc, 0
    s_cselect_b32 s9, 512, s9
    v_mov_b32 v21, s9
    ds_write_b32 v31, v21
    v_mov_b32 v31, 161792
    s_waitcnt vmcnt(8) lgkmcnt(0)
    s_barrier
    ds_read_b128 v[36:39], v31
    ds_read_b128 v[40:43], v31 offset:16
    s_sub_u32 s79, 153600, s15
    v_add_u32 v32, s79, v8
    v_add_u32 v33, s79, v9
    v_add_u32 v34, s79, v10
    v_add_u32 v35, s79, v11
    ds_read_b128 v[68:71], v32 offset:0
    ds_read_b128 v[72:75], v33 offset:0
    ds_read_b128 v[76:79], v34 offset:0
    ds_read_b128 v[80:83], v35 offset:0
    ds_read_b128 v[84:87], v32 offset:4096
    ds_read_b128 v[88:91], v33 offset:4096
    ds_read_b128 v[92:95], v34 offset:4096
    ds_read_b128 v[96:99], v35 offset:4096
    s_waitcnt lgkmcnt(8)
    v_min3_u32 v36, v36, v37, v38
    v_min3_u32 v39, v39, v40, v41
    v_min3_u32 v36, v36, v42, v43
    v_min_u32 v36, v36, v39
    s_nop 0
    v_readfirstlane_b32 s9, v36
    s_min_u32 s10, s10, s9
    s_mov_b32 s56, s10
    s_sub_i32 s79, s65, s9
    s_max_i32 s79, s79, 0
    s_add_u32 s57, s56, s79
    s_sub_i32 s65, s9, s56
    s_sub_i32 s79, s66, s9
    s_max_i32 s79, s79, 0
    s_add_u32 s58, s57, s79
    s_sub_i32 s66, s9, s57
    s_addk_i32 s66, 512
    s_sub_i32 s79, s67, s9
    s_max_i32 s79, s79, 0
    s_add_u32 s59, s58, s79
    s_sub_i32 s67, s9, s58
    s_addk_i32 s67, 1024
    s_sub_i32 s79, s68, s9
    s_max_i32 s79, s79, 0
    s_add_u32 s60, s59, s79
    s_sub_i32 s68, s9, s59
    s_addk_i32 s68, 1536
    s_sub_i32 s79, s69, s9
    s_max_i32 s79, s79, 0
    s_add_u32 s61, s60, s79
    s_sub_i32 s69, s9, s60
    s_addk_i32 s69, 2048
    s_sub_i32 s79, s70, s9
    s_max_i32 s79, s79, 0
    s_add_u32 s62, s61, s79
    s_sub_i32 s70, s9, s61
    s_addk_i32 s70, 2560
    s_sub_i32 s79, s71, s9
    s_max_i32 s79, s79, 0
    s_add_u32 s63, s62, s79
    s_sub_i32 s71, s9, s62
    s_addk_i32 s71, 3072
    s_sub_i32 s79, s72, s9
    s_max_i32 s79, s79, 0
    s_add_u32 s64, s63, s79
    s_sub_i32 s72, s9, s63
    s_addk_i32 s72, 3584
    v_cvt_f32_u32 v36, s64
    v_cvt_f32_u32 v37, s10
    v_cvt_f32_u32 v38, s11
    v_rcp_f32 v39, v36
    v_mul_f32 v37, 0x3f8fd1fa, v37
    v_mul_f32 v37, v37, v38
    v_mul_f32 v37, v37, v39
    v_ceil_f32 v37, v37
    v_min_f32 v37, v37, v38
    v_mov_b32 v39, 0xbde147ae
    v_subrev_f32 v40, 0x42000000, v38
    v_max_f32 v40, 0, v40
    v_mul_f32 v40, 0xbe2e147b, v40
    v_add_f32 v38, v38, v40
    v_fma_f32 v38, v37, v39, v38
    v_rcp_f32 v38, v38
    v_cvt_f32_u32 v40, v1
    v_mul_f32 v38, v38, v36
    v_add_f32 v41, 1.0, v40
    v_min_f32 v42, v40, v37
    v_fma_f32 v42, v42, v39, v40
    v_subrev_f32 v40, 0x42000000, v40
    v_max_f32 v40, 0, v40
    v_mul_f32 v40, 0xbe2e147b, v40
    v_add_f32 v42, v42, v40
    v_fma_f32 v42, v42, v38, 0.5
    v_cvt_u32_f32 v42, v42
    v_min_f32 v43, v41, v37
    v_fma_f32 v43, v43, v39, v41
    v_subrev_f32 v41, 0x42000000, v41
    v_max_f32 v41, 0, v41
    v_mul_f32 v41, 0xbe2e147b, v41
    v_add_f32 v43, v43, v41
    v_fma_f32 v43, v43, v38, 0.5
    v_cvt_u32_f32 v43, v43
    v_add_u32 v40, 1, v1
    v_mov_b32 v36, s64
    v_cmp_le_u32 vcc, s11, v40
    v_min_u32 v42, v42, v36
    v_min_u32 v43, v43, v36
    v_cndmask_b32 v43, v43, v36, vcc
    v_cmp_le_u32 vcc, s11, v1
    s_nop 1
    v_cndmask_b32 v42, v42, v36, vcc
    s_nop 0
    v_readlane_b32 s12, v42, s5
    v_readlane_b32 s13, v43, s5
    v_mul_u32_u24 v36, 8, v1
    s_sub_u32 s79, s13, s12
    s_max_i32 s79, s79, 0
    s_lshr_b32 s79, s79, 3
    s_lshl_b32 s100, s79, 2
    v_lshlrev_b32 v37, 2, v1
    v_add_u32 v37, s100, v37
    v_min_u32 v36, v36, v37
    s_lshl_b32 s79, s79, 3
    s_add_u32 s79, s79, s12
    s_cmp_lt_u32 s3, 4
    s_cselect_b32 s6, s13, s79
    v_mov_b32 v37, 0
    s_add_u32 s79, s12, s3
    v_add_u32 v36, s79, v36
    v_cmpx_le_u32 vcc, s56, v36
    v_mov_b32 v37, s65
    v_cmpx_le_u32 vcc, s57, v36
    v_mov_b32 v37, s66
    v_cmpx_le_u32 vcc, s58, v36
    v_mov_b32 v37, s67
    v_cmpx_le_u32 vcc, s59, v36
    v_mov_b32 v37, s68
    v_cmpx_le_u32 vcc, s60, v36
    v_mov_b32 v37, s69
    v_cmpx_le_u32 vcc, s61, v36
    v_mov_b32 v37, s70
    v_cmpx_le_u32 vcc, s62, v36
    v_mov_b32 v37, s71
    v_cmpx_le_u32 vcc, s63, v36
    v_mov_b32 v37, s72
    s_mov_b64 exec, -1
    v_add_u32 v37, v36, v37
    v_and_b32 v37, 4095, v37
    v_lshlrev_b32 v30, 2, v37
    v_add_u32 v30, 137216, v30
    ds_read_b32 v31, v30
    v_and_b32 v13, 511, v37
    v_lshlrev_b32 v13, 4, v13
    v_lshrrev_b32 v21, 9, v37
    v_cmp_gt_u32 vcc, s10, v36
    v_mov_b32 v24, 8
    v_cmp_gt_u32 s[96:97], s6, v36
    v_cndmask_b32 v21, v21, v24, vcc
    v_lshl_or_b32 v13, v21, 16, v13
    v_mov_b32 v24, 0x80000000
    s_bcnt1_i32_b64 s8, s[96:97]
    s_waitcnt lgkmcnt(0)
    v_lshlrev_b32 v31, 15, v31
    v_cndmask_b32 v12, v24, v31, s[96:97]
    s_nop 0
    v_readlane_b32 s88, v12, 0
    v_readlane_b32 s89, v12, 1
    s_nop 0
    s_cmp_lg_u32 s88, s84
    s_cbranch_scc1 L_mispec
L_specok:
    s_add_u32 m0, s15, 4096
    s_nop 0
    buffer_load_dwordx4 v2, s[40:43], s89 offen offset:0 nt lds
    buffer_load_dwordx4 v3, s[40:43], s89 offen offset:1024 nt lds
    buffer_load_dwordx4 v4, s[40:43], s89 offen offset:2048 nt lds
    buffer_load_dwordx4 v5, s[40:43], s89 offen offset:3072 nt lds
    buffer_load_dwordx4 v[180:183], v6, s[44:47], s89 offen offset:0 nt
    buffer_load_dwordx4 v[184:187], v6, s[44:47], s89 offen offset:2048 nt
    buffer_load_dwordx4 v[188:191], v7, s[44:47], s89 offen offset:0 nt
    buffer_load_dwordx4 v[192:195], v7, s[44:47], s89 offen offset:2048 nt
    s_lshl_b32 s79, s2, 3
    s_add_u32 s79, s79, s3
    s_cmp_lg_u32 s79, 1
    s_cbranch_scc1 L_nonon
    s_memrealtime s[96:97]
    v_mov_b32 v29, 0
    v_mov_b32 v26, 128
    s_waitcnt lgkmcnt(0)
    s_or_b32 s18, s96, 1
    v_mov_b32 v28, s18
    s_mov_b64 exec, 1
    global_atomic_cmpswap v0, v26, v[28:29], s[28:29] sc0 sc1
    s_mov_b64 exec, -1
L_nonon:
    s_cmp_eq_u32 s16, 0
    s_cbranch_scc0 L_zq
L_noz:
    s_mov_b32 s94, s56
    s_mov_b32 s95, s57
    s_cmp_eq_u32 s3, 1
    s_cselect_b32 s94, s57, s94
    s_cselect_b32 s95, s58, s95
    s_cmp_eq_u32 s3, 2
    s_cselect_b32 s94, s58, s94
    s_cselect_b32 s95, s59, s95
    s_cmp_eq_u32 s3, 3
    s_cselect_b32 s94, s59, s94
    s_cselect_b32 s95, s60, s95
    s_cmp_eq_u32 s3, 4
    s_cselect_b32 s94, s60, s94
    s_cselect_b32 s95, s61, s95
    s_cmp_eq_u32 s3, 5
    s_cselect_b32 s94, s61, s94
    s_cselect_b32 s95, s62, s95
    s_cmp_eq_u32 s3, 6
    s_cselect_b32 s94, s62, s94
    s_cselect_b32 s95, s63, s95
    s_cmp_eq_u32 s3, 7
    s_cselect_b32 s94, s63, s94
    s_cselect_b32 s95, s64, s95
    v_cmp_lt_u32 s[84:85], v42, v43
    v_cmp_gt_u32 s[86:87], s10, v42
    v_cmp_gt_u32 s[88:89], s95, v42
    v_cmp_lt_u32 s[90:91], s94, v43
    s_and_b64 s[88:89], s[88:89], s[90:91]
    s_cmp_lt_u32 s94, s95
    s_cselect_b64 s[88:89], s[88:89], 0
    s_or_b64 s[86:87], s[86:87], s[88:89]
    s_and_b64 s[92:93], s[86:87], s[84:85]
    s_bcnt1_i32_b64 s17, s[92:93]
    s_max_u32 s79, s12, s56
    s_min_u32 s100, s13, s60
    s_cmp_lt_u32 s79, s100
    s_cselect_b32 s98, 1, 0
    s_cmp_lt_u32 s12, s10
    s_cselect_b32 s98, 1, s98
    s_max_u32 s79, s12, s60
    s_min_u32 s100, s13, s64
    s_cmp_lt_u32 s79, s100
    s_cselect_b32 s99, 1, 0
    s_cmp_lt_u32 s12, s10
    s_cselect_b32 s99, 1, s99
    v_and_b32 v30, 15, v1
    v_lshrrev_b32 v21, 4, v1
    s_lshl_b32 s79, s3, 8
    s_add_u32 s79, s79, 135168
    v_lshlrev_b32 v214, 3, v30
    v_add_u32 v214, s79, v214
    v_mul_u32_u24 v215, 528, v30
    v_lshl_add_u32 v215, v21, 7, v215
    v_add_u32 v215, s15, v215
    s_lshl_b32 s79, s3, 2
    v_add_u32 v21, s79, v21
    v_lshlrev_b32 v216, 3, v21
    v_add_u32 v216, 135168, v216
    v_mul_u32_u24 v217, 528, v21
    v_lshl_add_u32 v217, v30, 5, v217
    v_add_u32 v218, 67584, v217
    v_lshlrev_b32 v221, 4, v1
    v_mov_b32 v222, 161824
    s_mov_b32 s48, s30
    s_mov_b32 s49, s31
    s_mov_b32 s50, 16777216
    s_mov_b32 s52, s26
    s_mov_b32 s53, s27
    s_lshl_b32 s79, s4, 9
    s_add_u32 s79, s79, s3
    s_lshl_b32 s94, s79, 12
    s_lshl_b32 s33, s3, 13
    s_lshl_b32 s100, s4, 10
    s_add_u32 s33, s33, s100
    s_lshl_b32 s79, s4, 4
    v_mov_b32 v220, s79
    s_lshl_b32 s95, s3, 3
    s_lshl_b64 s[96:97], 1, s95
    s_cmp_lt_u32 s12, s10
    s_cselect_b32 s34, 1, 0
    s_cselect_b32 s96, 0x01010101, s96
    s_cselect_b32 s97, 0x01010101, s97
    s_cselect_b32 s35, s3, 0
    v_mov_b32 v212, s96
    v_mov_b32 v213, s97
    s_bitcmp1_b64 s[92:93], s5
    s_cselect_b32 s36, 1, 0
    s_bitset0_b64 s[92:93], s5
    s_bcnt1_i32_b64 s37, s[92:93]
    s_min_u32 s37, s37, 12
    s_ff1_i32_b64 s79, s[92:93]
    s_bitset0_b64 s[92:93], s79
    s_lshl_b32 s79, s79, 15
    s_add_u32 s67, s79, s94
    s_ff1_i32_b64 s79, s[92:93]
    s_bitset0_b64 s[92:93], s79
    s_lshl_b32 s79, s79, 15
    s_add_u32 s66, s79, s94
    s_ff1_i32_b64 s79, s[92:93]
    s_bitset0_b64 s[92:93], s79
    s_lshl_b32 s79, s79, 15
    s_add_u32 s65, s79, s94
    s_ff1_i32_b64 s79, s[92:93]
    s_bitset0_b64 s[92:93], s79
    s_lshl_b32 s79, s79, 15
    s_add_u32 s64, s79, s94
    s_ff1_i32_b64 s79, s[92:93]
    s_bitset0_b64 s[92:93], s79
    s_lshl_b32 s79, s79, 15
    s_add_u32 s63, s79, s94
    s_ff1_i32_b64 s79, s[92:93]
    s_bitset0_b64 s[92:93], s79
    s_lshl_b32 s79, s79, 15
    s_add_u32 s62, s79, s94
    s_ff1_i32_b64 s79, s[92:93]
    s_bitset0_b64 s[92:93], s79
    s_lshl_b32 s79, s79, 15
    s_add_u32 s61, s79, s94
    s_ff1_i32_b64 s79, s[92:93]
    s_bitset0_b64 s[92:93], s79
    s_lshl_b32 s79, s79, 15
    s_add_u32 s60, s79, s94
    s_ff1_i32_b64 s79, s[92:93]
    s_bitset0_b64 s[92:93], s79
    s_lshl_b32 s79, s79, 15
    s_add_u32 s59, s79, s94
    s_ff1_i32_b64 s79, s[92:93]
    s_bitset0_b64 s[92:93], s79
    s_lshl_b32 s79, s79, 15
    s_add_u32 s58, s79, s94
    s_ff1_i32_b64 s79, s[92:93]
    s_bitset0_b64 s[92:93], s79
    s_lshl_b32 s79, s79, 15
    s_add_u32 s57, s79, s94
    s_ff1_i32_b64 s79, s[92:93]
    s_bitset0_b64 s[92:93], s79
    s_lshl_b32 s79, s79, 15
    s_add_u32 s56, s79, s94
    s_sub_u32 s17, s17, 1
    s_lshl_b32 s32, s5, 15
    s_add_u32 s32, s32, s94
    s_mov_b32 s6, 0
    s_mov_b32 s7, 2
    s_cmp_eq_u32 s8, 0
    s_cbranch_scc1 L_loopdone
L_loop:
    v_readlane_b32 s76, v12, s7
    v_readlane_b32 s75, v13, s6
    s_add_u32 m0, s15, 0
    s_sub_u32 s79, s8, s6
    s_cmp_gt_u32 s79, 1
    s_cbranch_scc1 L_w1_0
    s_waitcnt vmcnt(0)
L_w1_0:
    s_waitcnt vmcnt(8)
    s_cmp_lt_u32 s7, s8
    s_cselect_b32 s100, 1, 0
    ds_read_b128 v[36:39], v8 offset:0
    ds_read_b128 v[40:43], v9 offset:0
    ds_read_b128 v[44:47], v10 offset:0
    ds_read_b128 v[48:51], v11 offset:0
    v_perm_b32 v52, v168, v164, s77
    v_perm_b32 v53, v176, v172, s77
    v_perm_b32 v54, v168, v164, s78
    v_perm_b32 v55, v176, v172, s78
    v_perm_b32 v56, v169, v165, s77
    v_perm_b32 v57, v177, v173, s77
    v_perm_b32 v58, v169, v165, s78
    v_perm_b32 v59, v177, v173, s78
    v_perm_b32 v60, v170, v166, s77
    v_perm_b32 v61, v178, v174, s77
    v_perm_b32 v62, v170, v166, s78
    v_perm_b32 v63, v178, v174, s78
    v_perm_b32 v64, v171, v167, s77
    v_perm_b32 v65, v179, v175, s77
    v_perm_b32 v66, v171, v167, s78
    v_perm_b32 v67, v179, v175, s78
    s_cmp_eq_u32 s100, 0
    s_cbranch_scc1 L_nv_0
    buffer_load_dwordx4 v[164:167], v6, s[44:47], s76 offen offset:0 nt
    buffer_load_dwordx4 v[168:171], v6, s[44:47], s76 offen offset:2048 nt
    buffer_load_dwordx4 v[172:175], v7, s[44:47], s76 offen offset:0 nt
    buffer_load_dwordx4 v[176:179], v7, s[44:47], s76 offen offset:2048 nt
L_nv_0:
    s_and_b32 s73, s75, 0xffff
    s_lshr_b32 s74, s75, 16
    s_and_b32 s79, s74, 3
    s_lshl_b32 s79, s79, 2
    s_lshl_b64 s[80:81], s[82:83], s79
    s_cmp_eq_u32 s74, 8
    s_cselect_b64 s[80:81], -1, s[80:81]
    s_waitcnt lgkmcnt(0)
    s_cmp_eq_u32 s100, 0
    s_cbranch_scc1 L_nk_0
    buffer_load_dwordx4 v2, s[40:43], s76 offen offset:0 nt lds
    buffer_load_dwordx4 v3, s[40:43], s76 offen offset:1024 nt lds
    buffer_load_dwordx4 v4, s[40:43], s76 offen offset:2048 nt lds
    buffer_load_dwordx4 v5, s[40:43], s76 offen offset:3072 nt lds
L_nk_0:
    s_bitcmp1_b32 s74, 2
    s_cbranch_scc1 L_g1_0
    v_mfma_f32_16x16x32_bf16 v[32:35], v[36:39], v[68:71], 0
    v_mfma_f32_16x16x32_bf16 v[32:35], v[40:43], v[72:75], v[32:35]
    v_mfma_f32_16x16x32_bf16 v[32:35], v[44:47], v[76:79], v[32:35]
    v_mfma_f32_16x16x32_bf16 v[32:35], v[48:51], v[80:83], v[32:35]
    v_subrev_u32 v26, s73, v14
    v_cndmask_b32 v26, 0, v26, s[80:81]
    v_cmp_lt_i32 s[84:85], 0, v26
    v_cmp_lt_i32 s[86:87], 1, v26
    v_cmp_lt_i32 s[88:89], 2, v26
    v_cmp_lt_i32 s[90:91], 3, v26
    s_nop 1
    v_cndmask_b32 v32, v16, v32, s[84:85]
    v_cndmask_b32 v33, v16, v33, s[86:87]
    v_cndmask_b32 v34, v16, v34, s[88:89]
    v_cndmask_b32 v35, v16, v35, s[90:91]
    v_max3_f32 v21, v32, v33, v34
    v_max3_f32 v21, v21, v35, v17
    v_mov_b32 v24, v21
    s_nop 1
    v_permlane32_swap_b32 v21, v24
    v_max_f32 v21, v21, v24
    v_mov_b32 v24, v21
    s_nop 1
    v_permlane16_swap_b32 v21, v24
    v_max_f32 v27, v21, v24
    v_sub_f32 v21, v17, v27
    v_mul_f32 v25, s14, v27
    v_mul_f32 v21, s14, v21
    v_exp_f32 v22, v21
    v_fma_f32 v32, v32, s14, -v25
    v_fma_f32 v33, v33, s14, -v25
    v_fma_f32 v34, v34, s14, -v25
    v_fma_f32 v35, v35, s14, -v25
    v_exp_f32 v32, v32
    v_exp_f32 v33, v33
    v_exp_f32 v34, v34
    v_exp_f32 v35, v35
    v_pk_mul_f32 v[100:101], v[100:101], v[22:23] op_sel_hi:[1,0]
    v_pk_mul_f32 v[102:103], v[102:103], v[22:23] op_sel_hi:[1,0]
    v_cvt_pk_bf16_f32 v28, v32, v33
    v_cvt_pk_bf16_f32 v29, v34, v35
    v_pk_mul_f32 v[104:105], v[104:105], v[22:23] op_sel_hi:[1,0]
    v_pk_mul_f32 v[106:107], v[106:107], v[22:23] op_sel_hi:[1,0]
    v_mfma_f32_16x16x16_bf16 v[100:103], v[52:53], v[28:29], v[100:103]
    v_pk_mul_f32 v[108:109], v[108:109], v[22:23] op_sel_hi:[1,0]
    v_pk_mul_f32 v[110:111], v[110:111], v[22:23] op_sel_hi:[1,0]
    v_mfma_f32_16x16x16_bf16 v[104:107], v[54:55], v[28:29], v[104:107]
    v_pk_mul_f32 v[112:113], v[112:113], v[22:23] op_sel_hi:[1,0]
    v_pk_mul_f32 v[114:115], v[114:115], v[22:23] op_sel_hi:[1,0]
    v_mfma_f32_16x16x16_bf16 v[108:111], v[56:57], v[28:29], v[108:111]
    v_pk_mul_f32 v[116:117], v[116:117], v[22:23] op_sel_hi:[1,0]
    v_pk_mul_f32 v[118:119], v[118:119], v[22:23] op_sel_hi:[1,0]
    v_mfma_f32_16x16x16_bf16 v[112:115], v[58:59], v[28:29], v[112:115]
    v_pk_mul_f32 v[120:121], v[120:121], v[22:23] op_sel_hi:[1,0]
    v_pk_mul_f32 v[122:123], v[122:123], v[22:23] op_sel_hi:[1,0]
    v_mfma_f32_16x16x16_bf16 v[116:119], v[60:61], v[28:29], v[116:119]
    v_pk_mul_f32 v[124:125], v[124:125], v[22:23] op_sel_hi:[1,0]
    v_pk_mul_f32 v[126:127], v[126:127], v[22:23] op_sel_hi:[1,0]
    v_mfma_f32_16x16x16_bf16 v[120:123], v[62:63], v[28:29], v[120:123]
    v_pk_mul_f32 v[128:129], v[128:129], v[22:23] op_sel_hi:[1,0]
    v_pk_mul_f32 v[130:131], v[130:131], v[22:23] op_sel_hi:[1,0]
    v_mfma_f32_16x16x16_bf16 v[124:127], v[64:65], v[28:29], v[124:127]
    v_fma_f32 v19, v19, v22, v32
    v_add_f32 v21, v33, v34
    v_mfma_f32_16x16x16_bf16 v[128:131], v[66:67], v[28:29], v[128:131]
    v_add_f32 v19, v19, v35
    v_add_f32 v19, v19, v21
    v_mov_b32 v17, v27
    s_cmp_lt_u32 s74, 4
    s_cbranch_scc1 L_next_0
L_g1_0:
    v_mfma_f32_16x16x32_bf16 v[32:35], v[36:39], v[84:87], 0
    v_mfma_f32_16x16x32_bf16 v[32:35], v[40:43], v[88:91], v[32:35]
    v_mfma_f32_16x16x32_bf16 v[32:35], v[44:47], v[92:95], v[32:35]
    v_mfma_f32_16x16x32_bf16 v[32:35], v[48:51], v[96:99], v[32:35]
    v_subrev_u32 v26, s73, v15
    v_cndmask_b32 v26, 0, v26, s[80:81]
    v_cmp_lt_i32 s[84:85], 0, v26
    v_cmp_lt_i32 s[86:87], 1, v26
    v_cmp_lt_i32 s[88:89], 2, v26
    v_cmp_lt_i32 s[90:91], 3, v26
    s_nop 1
    v_cndmask_b32 v32, v16, v32, s[84:85]
    v_cndmask_b32 v33, v16, v33, s[86:87]
    v_cndmask_b32 v34, v16, v34, s[88:89]
    v_cndmask_b32 v35, v16, v35, s[90:91]
    v_max3_f32 v21, v32, v33, v34
    v_max3_f32 v21, v21, v35, v18
    v_mov_b32 v24, v21
    s_nop 1
    v_permlane32_swap_b32 v21, v24
    v_max_f32 v21, v21, v24
    v_mov_b32 v24, v21
    s_nop 1
    v_permlane16_swap_b32 v21, v24
    v_max_f32 v27, v21, v24
    v_sub_f32 v21, v18, v27
    v_mul_f32 v25, s14, v27
    v_mul_f32 v21, s14, v21
    v_exp_f32 v22, v21
    v_fma_f32 v32, v32, s14, -v25
    v_fma_f32 v33, v33, s14, -v25
    v_fma_f32 v34, v34, s14, -v25
    v_fma_f32 v35, v35, s14, -v25
    v_exp_f32 v32, v32
    v_exp_f32 v33, v33
    v_exp_f32 v34, v34
    v_exp_f32 v35, v35
    v_pk_mul_f32 v[132:133], v[132:133], v[22:23] op_sel_hi:[1,0]
    v_pk_mul_f32 v[134:135], v[134:135], v[22:23] op_sel_hi:[1,0]
    v_cvt_pk_bf16_f32 v28, v32, v33
    v_cvt_pk_bf16_f32 v29, v34, v35
    v_pk_mul_f32 v[136:137], v[136:137], v[22:23] op_sel_hi:[1,0]
    v_pk_mul_f32 v[138:139], v[138:139], v[22:23] op_sel_hi:[1,0]
    v_mfma_f32_16x16x16_bf16 v[132:135], v[52:53], v[28:29], v[132:135]
    v_pk_mul_f32 v[140:141], v[140:141], v[22:23] op_sel_hi:[1,0]
    v_pk_mul_f32 v[142:143], v[142:143], v[22:23] op_sel_hi:[1,0]
    v_mfma_f32_16x16x16_bf16 v[136:139], v[54:55], v[28:29], v[136:139]
    v_pk_mul_f32 v[144:145], v[144:145], v[22:23] op_sel_hi:[1,0]
    v_pk_mul_f32 v[146:147], v[146:147], v[22:23] op_sel_hi:[1,0]
    v_mfma_f32_16x16x16_bf16 v[140:143], v[56:57], v[28:29], v[140:143]
    v_pk_mul_f32 v[148:149], v[148:149], v[22:23] op_sel_hi:[1,0]
    v_pk_mul_f32 v[150:151], v[150:151], v[22:23] op_sel_hi:[1,0]
    v_mfma_f32_16x16x16_bf16 v[144:147], v[58:59], v[28:29], v[144:147]
    v_pk_mul_f32 v[152:153], v[152:153], v[22:23] op_sel_hi:[1,0]
    v_pk_mul_f32 v[154:155], v[154:155], v[22:23] op_sel_hi:[1,0]
    v_mfma_f32_16x16x16_bf16 v[148:151], v[60:61], v[28:29], v[148:151]
    v_pk_mul_f32 v[156:157], v[156:157], v[22:23] op_sel_hi:[1,0]
    v_pk_mul_f32 v[158:159], v[158:159], v[22:23] op_sel_hi:[1,0]
    v_mfma_f32_16x16x16_bf16 v[152:155], v[62:63], v[28:29], v[152:155]
    v_pk_mul_f32 v[160:161], v[160:161], v[22:23] op_sel_hi:[1,0]
    v_pk_mul_f32 v[162:163], v[162:163], v[22:23] op_sel_hi:[1,0]
    v_mfma_f32_16x16x16_bf16 v[156:159], v[64:65], v[28:29], v[156:159]
    v_fma_f32 v20, v20, v22, v32
    v_add_f32 v21, v33, v34
    v_mfma_f32_16x16x16_bf16 v[160:163], v[66:67], v[28:29], v[160:163]
    v_add_f32 v20, v20, v35
    v_add_f32 v20, v20, v21
    v_mov_b32 v18, v27
L_next_0:
    s_add_u32 s6, s6, 1
    s_add_u32 s7, s7, 1
    s_cmp_ge_u32 s6, s8
    s_cbranch_scc1 L_loopdone
    v_readlane_b32 s76, v12, s7
    v_readlane_b32 s75, v13, s6
    s_add_u32 m0, s15, 4096
    s_sub_u32 s79, s8, s6
    s_cmp_gt_u32 s79, 1
    s_cbranch_scc1 L_w1_1
    s_waitcnt vmcnt(0)
L_w1_1:
    s_waitcnt vmcnt(8)
    s_cmp_lt_u32 s7, s8
    s_cselect_b32 s100, 1, 0
    ds_read_b128 v[36:39], v8 offset:4096
    ds_read_b128 v[40:43], v9 offset:4096
    ds_read_b128 v[44:47], v10 offset:4096
    ds_read_b128 v[48:51], v11 offset:4096
    v_perm_b32 v52, v184, v180, s77
    v_perm_b32 v53, v192, v188, s77
    v_perm_b32 v54, v184, v180, s78
    v_perm_b32 v55, v192, v188, s78
    v_perm_b32 v56, v185, v181, s77
    v_perm_b32 v57, v193, v189, s77
    v_perm_b32 v58, v185, v181, s78
    v_perm_b32 v59, v193, v189, s78
    v_perm_b32 v60, v186, v182, s77
    v_perm_b32 v61, v194, v190, s77
    v_perm_b32 v62, v186, v182, s78
    v_perm_b32 v63, v194, v190, s78
    v_perm_b32 v64, v187, v183, s77
    v_perm_b32 v65, v195, v191, s77
    v_perm_b32 v66, v187, v183, s78
    v_perm_b32 v67, v195, v191, s78
    s_cmp_eq_u32 s100, 0
    s_cbranch_scc1 L_nv_1
    buffer_load_dwordx4 v[180:183], v6, s[44:47], s76 offen offset:0 nt
    buffer_load_dwordx4 v[184:187], v6, s[44:47], s76 offen offset:2048 nt
    buffer_load_dwordx4 v[188:191], v7, s[44:47], s76 offen offset:0 nt
    buffer_load_dwordx4 v[192:195], v7, s[44:47], s76 offen offset:2048 nt
L_nv_1:
    s_and_b32 s73, s75, 0xffff
    s_lshr_b32 s74, s75, 16
    s_and_b32 s79, s74, 3
    s_lshl_b32 s79, s79, 2
    s_lshl_b64 s[80:81], s[82:83], s79
    s_cmp_eq_u32 s74, 8
    s_cselect_b64 s[80:81], -1, s[80:81]
    s_waitcnt lgkmcnt(0)
    s_cmp_eq_u32 s100, 0
    s_cbranch_scc1 L_nk_1
    buffer_load_dwordx4 v2, s[40:43], s76 offen offset:0 nt lds
    buffer_load_dwordx4 v3, s[40:43], s76 offen offset:1024 nt lds
    buffer_load_dwordx4 v4, s[40:43], s76 offen offset:2048 nt lds
    buffer_load_dwordx4 v5, s[40:43], s76 offen offset:3072 nt lds
L_nk_1:
    s_bitcmp1_b32 s74, 2
    s_cbranch_scc1 L_g1_1
    v_mfma_f32_16x16x32_bf16 v[32:35], v[36:39], v[68:71], 0
    v_mfma_f32_16x16x32_bf16 v[32:35], v[40:43], v[72:75], v[32:35]
    v_mfma_f32_16x16x32_bf16 v[32:35], v[44:47], v[76:79], v[32:35]
    v_mfma_f32_16x16x32_bf16 v[32:35], v[48:51], v[80:83], v[32:35]
    v_subrev_u32 v26, s73, v14
    v_cndmask_b32 v26, 0, v26, s[80:81]
    v_cmp_lt_i32 s[84:85], 0, v26
    v_cmp_lt_i32 s[86:87], 1, v26
    v_cmp_lt_i32 s[88:89], 2, v26
    v_cmp_lt_i32 s[90:91], 3, v26
    s_nop 1
    v_cndmask_b32 v32, v16, v32, s[84:85]
    v_cndmask_b32 v33, v16, v33, s[86:87]
    v_cndmask_b32 v34, v16, v34, s[88:89]
    v_cndmask_b32 v35, v16, v35, s[90:91]
    v_max3_f32 v21, v32, v33, v34
    v_max3_f32 v21, v21, v35, v17
    v_mov_b32 v24, v21
    s_nop 1
    v_permlane32_swap_b32 v21, v24
    v_max_f32 v21, v21, v24
    v_mov_b32 v24, v21
    s_nop 1
    v_permlane16_swap_b32 v21, v24
    v_max_f32 v27, v21, v24
    v_sub_f32 v21, v17, v27
    v_mul_f32 v25, s14, v27
    v_mul_f32 v21, s14, v21
    v_exp_f32 v22, v21
    v_fma_f32 v32, v32, s14, -v25
    v_fma_f32 v33, v33, s14, -v25
    v_fma_f32 v34, v34, s14, -v25
    v_fma_f32 v35, v35, s14, -v25
    v_exp_f32 v32, v32
    v_exp_f32 v33, v33
    v_exp_f32 v34, v34
    v_exp_f32 v35, v35
    v_pk_mul_f32 v[100:101], v[100:101], v[22:23] op_sel_hi:[1,0]
    v_pk_mul_f32 v[102:103], v[102:103], v[22:23] op_sel_hi:[1,0]
    v_cvt_pk_bf16_f32 v28, v32, v33
    v_cvt_pk_bf16_f32 v29, v34, v35
    v_pk_mul_f32 v[104:105], v[104:105], v[22:23] op_sel_hi:[1,0]
    v_pk_mul_f32 v[106:107], v[106:107], v[22:23] op_sel_hi:[1,0]
    v_mfma_f32_16x16x16_bf16 v[100:103], v[52:53], v[28:29], v[100:103]
    v_pk_mul_f32 v[108:109], v[108:109], v[22:23] op_sel_hi:[1,0]
    v_pk_mul_f32 v[110:111], v[110:111], v[22:23] op_sel_hi:[1,0]
    v_mfma_f32_16x16x16_bf16 v[104:107], v[54:55], v[28:29], v[104:107]
    v_pk_mul_f32 v[112:113], v[112:113], v[22:23] op_sel_hi:[1,0]
    v_pk_mul_f32 v[114:115], v[114:115], v[22:23] op_sel_hi:[1,0]
    v_mfma_f32_16x16x16_bf16 v[108:111], v[56:57], v[28:29], v[108:111]
    v_pk_mul_f32 v[116:117], v[116:117], v[22:23] op_sel_hi:[1,0]
    v_pk_mul_f32 v[118:119], v[118:119], v[22:23] op_sel_hi:[1,0]
    v_mfma_f32_16x16x16_bf16 v[112:115], v[58:59], v[28:29], v[112:115]
    v_pk_mul_f32 v[120:121], v[120:121], v[22:23] op_sel_hi:[1,0]
    v_pk_mul_f32 v[122:123], v[122:123], v[22:23] op_sel_hi:[1,0]
    v_mfma_f32_16x16x16_bf16 v[116:119], v[60:61], v[28:29], v[116:119]
    v_pk_mul_f32 v[124:125], v[124:125], v[22:23] op_sel_hi:[1,0]
    v_pk_mul_f32 v[126:127], v[126:127], v[22:23] op_sel_hi:[1,0]
    v_mfma_f32_16x16x16_bf16 v[120:123], v[62:63], v[28:29], v[120:123]
    v_pk_mul_f32 v[128:129], v[128:129], v[22:23] op_sel_hi:[1,0]
    v_pk_mul_f32 v[130:131], v[130:131], v[22:23] op_sel_hi:[1,0]
    v_mfma_f32_16x16x16_bf16 v[124:127], v[64:65], v[28:29], v[124:127]
    v_fma_f32 v19, v19, v22, v32
    v_add_f32 v21, v33, v34
    v_mfma_f32_16x16x16_bf16 v[128:131], v[66:67], v[28:29], v[128:131]
    v_add_f32 v19, v19, v35
    v_add_f32 v19, v19, v21
    v_mov_b32 v17, v27
    s_cmp_lt_u32 s74, 4
    s_cbranch_scc1 L_next_1
L_g1_1:
    v_mfma_f32_16x16x32_bf16 v[32:35], v[36:39], v[84:87], 0
    v_mfma_f32_16x16x32_bf16 v[32:35], v[40:43], v[88:91], v[32:35]
    v_mfma_f32_16x16x32_bf16 v[32:35], v[44:47], v[92:95], v[32:35]
    v_mfma_f32_16x16x32_bf16 v[32:35], v[48:51], v[96:99], v[32:35]
    v_subrev_u32 v26, s73, v15
    v_cndmask_b32 v26, 0, v26, s[80:81]
    v_cmp_lt_i32 s[84:85], 0, v26
    v_cmp_lt_i32 s[86:87], 1, v26
    v_cmp_lt_i32 s[88:89], 2, v26
    v_cmp_lt_i32 s[90:91], 3, v26
    s_nop 1
    v_cndmask_b32 v32, v16, v32, s[84:85]
    v_cndmask_b32 v33, v16, v33, s[86:87]
    v_cndmask_b32 v34, v16, v34, s[88:89]
    v_cndmask_b32 v35, v16, v35, s[90:91]
    v_max3_f32 v21, v32, v33, v34
    v_max3_f32 v21, v21, v35, v18
    v_mov_b32 v24, v21
    s_nop 1
    v_permlane32_swap_b32 v21, v24
    v_max_f32 v21, v21, v24
    v_mov_b32 v24, v21
    s_nop 1
    v_permlane16_swap_b32 v21, v24
    v_max_f32 v27, v21, v24
    v_sub_f32 v21, v18, v27
    v_mul_f32 v25, s14, v27
    v_mul_f32 v21, s14, v21
    v_exp_f32 v22, v21
    v_fma_f32 v32, v32, s14, -v25
    v_fma_f32 v33, v33, s14, -v25
    v_fma_f32 v34, v34, s14, -v25
    v_fma_f32 v35, v35, s14, -v25
    v_exp_f32 v32, v32
    v_exp_f32 v33, v33
    v_exp_f32 v34, v34
    v_exp_f32 v35, v35
    v_pk_mul_f32 v[132:133], v[132:133], v[22:23] op_sel_hi:[1,0]
    v_pk_mul_f32 v[134:135], v[134:135], v[22:23] op_sel_hi:[1,0]
    v_cvt_pk_bf16_f32 v28, v32, v33
    v_cvt_pk_bf16_f32 v29, v34, v35
    v_pk_mul_f32 v[136:137], v[136:137], v[22:23] op_sel_hi:[1,0]
    v_pk_mul_f32 v[138:139], v[138:139], v[22:23] op_sel_hi:[1,0]
    v_mfma_f32_16x16x16_bf16 v[132:135], v[52:53], v[28:29], v[132:135]
    v_pk_mul_f32 v[140:141], v[140:141], v[22:23] op_sel_hi:[1,0]
    v_pk_mul_f32 v[142:143], v[142:143], v[22:23] op_sel_hi:[1,0]
    v_mfma_f32_16x16x16_bf16 v[136:139], v[54:55], v[28:29], v[136:139]
    v_pk_mul_f32 v[144:145], v[144:145], v[22:23] op_sel_hi:[1,0]
    v_pk_mul_f32 v[146:147], v[146:147], v[22:23] op_sel_hi:[1,0]
    v_mfma_f32_16x16x16_bf16 v[140:143], v[56:57], v[28:29], v[140:143]
    v_pk_mul_f32 v[148:149], v[148:149], v[22:23] op_sel_hi:[1,0]
    v_pk_mul_f32 v[150:151], v[150:151], v[22:23] op_sel_hi:[1,0]
    v_mfma_f32_16x16x16_bf16 v[144:147], v[58:59], v[28:29], v[144:147]
    v_pk_mul_f32 v[152:153], v[152:153], v[22:23] op_sel_hi:[1,0]
    v_pk_mul_f32 v[154:155], v[154:155], v[22:23] op_sel_hi:[1,0]
    v_mfma_f32_16x16x16_bf16 v[148:151], v[60:61], v[28:29], v[148:151]
    v_pk_mul_f32 v[156:157], v[156:157], v[22:23] op_sel_hi:[1,0]
    v_pk_mul_f32 v[158:159], v[158:159], v[22:23] op_sel_hi:[1,0]
    v_mfma_f32_16x16x16_bf16 v[152:155], v[62:63], v[28:29], v[152:155]
    v_pk_mul_f32 v[160:161], v[160:161], v[22:23] op_sel_hi:[1,0]
    v_pk_mul_f32 v[162:163], v[162:163], v[22:23] op_sel_hi:[1,0]
    v_mfma_f32_16x16x16_bf16 v[156:159], v[64:65], v[28:29], v[156:159]
    v_fma_f32 v20, v20, v22, v32
    v_add_f32 v21, v33, v34
    v_mfma_f32_16x16x16_bf16 v[160:163], v[66:67], v[28:29], v[160:163]
    v_add_f32 v20, v20, v35
    v_add_f32 v20, v20, v21
    v_mov_b32 v18, v27
L_next_1:
    s_add_u32 s6, s6, 1
    s_add_u32 s7, s7, 1
    s_cmp_ge_u32 s6, s8
    s_cbranch_scc0 L_loop
L_loopdone:
    v_mov_b32 v24, v19
    v_mov_b32 v21, v20
    v_mov_b32 v32, v17
    v_permlane32_swap_b32 v19, v24
    v_permlane32_swap_b32 v20, v21
    v_add_f32 v19, v19, v24
    v_add_f32 v20, v20, v21
    v_mov_b32 v24, v19
    v_mov_b32 v21, v20
    v_mov_b32 v34, v18
    s_waitcnt vmcnt(0)
    v_permlane16_swap_b32 v19, v24
    v_permlane16_swap_b32 v20, v21
    v_add_f32 v33, v19, v24
    v_add_f32 v35, v20, v21
    s_cmp_eq_u32 s98, 0
    s_cbranch_scc1 L_skipw0
    ds_write_b128 v215, v[100:103] offset:0
    ds_write_b128 v215, v[104:107] offset:16
    ds_write_b128 v215, v[108:111] offset:32
    ds_write_b128 v215, v[112:115] offset:48
    ds_write_b128 v215, v[116:119] offset:64
    ds_write_b128 v215, v[120:123] offset:80
    ds_write_b128 v215, v[124:127] offset:96
    ds_write_b128 v215, v[128:131] offset:112
    ds_write_b64 v214, v[32:33] offset:0
L_skipw0:
    s_cmp_eq_u32 s99, 0
    s_cbranch_scc1 L_skipw1
    ds_write_b128 v215, v[132:135] offset:8448
    ds_write_b128 v215, v[136:139] offset:8464
    ds_write_b128 v215, v[140:143] offset:8480
    ds_write_b128 v215, v[144:147] offset:8496
    ds_write_b128 v215, v[148:151] offset:8512
    ds_write_b128 v215, v[152:155] offset:8528
    ds_write_b128 v215, v[156:159] offset:8544
    ds_write_b128 v215, v[160:163] offset:8560
    ds_write_b64 v214, v[34:35] offset:128
L_skipw1:
    s_cmp_eq_u32 s3, 1
    s_cbranch_scc1 L_nonget
L_nonon2:
    s_waitcnt lgkmcnt(0)
    s_barrier
    s_cmp_eq_u32 s36, 0
    s_cbranch_scc1 L_end
    s_cmp_lg_u32 s35, 0
    s_cbranch_scc1 L_notk
    s_mov_b64 exec, 1
    global_atomic_add_x2 v[212:213], v220, v[212:213], s[28:29] sc0 sc1
    s_mov_b64 exec, -1
L_notk:
    ds_read_b32 v33, v222
    ds_read_b64 v[36:37], v216 offset:0
    ds_read_b64 v[38:39], v216 offset:256
    ds_read_b64 v[40:41], v216 offset:512
    ds_read_b64 v[42:43], v216 offset:768
    ds_read_b64 v[44:45], v216 offset:1024
    ds_read_b64 v[46:47], v216 offset:1280
    ds_read_b64 v[48:49], v216 offset:1536
    ds_read_b64 v[50:51], v216 offset:1792
    ds_read_b128 v[100:103], v217 offset:0
    ds_read_b128 v[104:107], v217 offset:16
    ds_read_b128 v[108:111], v217 offset:16896
    ds_read_b128 v[112:115], v217 offset:16912
    ds_read_b128 v[116:119], v217 offset:33792
    ds_read_b128 v[120:123], v217 offset:33808
    s_waitcnt lgkmcnt(6)
    ds_read_b128 v[124:127], v217 offset:50688
    ds_read_b128 v[128:131], v217 offset:50704
    ds_read_b128 v[132:135], v218 offset:0
    ds_read_b128 v[136:139], v218 offset:16
    ds_read_b128 v[140:143], v218 offset:16896
    ds_read_b128 v[144:147], v218 offset:16912
    ds_read_b128 v[148:151], v218 offset:33792
    ds_read_b128 v[152:155], v218 offset:33808
    ds_read_b128 v[156:159], v218 offset:50688
    ds_read_b128 v[160:163], v218 offset:50704
    v_max3_f32 v34, v36, v38, v40
    v_max3_f32 v34, v34, v42, v44
    v_max3_f32 v34, v34, v46, v48
    v_max_f32 v34, v34, v50
    v_mul_f32 v34, s14, v34
    v_fma_f32 v36, v36, s14, -v34
    v_fma_f32 v38, v38, s14, -v34
    v_fma_f32 v40, v40, s14, -v34
    v_fma_f32 v42, v42, s14, -v34
    v_fma_f32 v44, v44, s14, -v34
    v_fma_f32 v46, v46, s14, -v34
    v_fma_f32 v48, v48, s14, -v34
    v_fma_f32 v50, v50, s14, -v34
    v_exp_f32 v36, v36
    v_exp_f32 v38, v38
    v_exp_f32 v40, v40
    v_exp_f32 v42, v42
    v_exp_f32 v44, v44
    v_exp_f32 v46, v46
    v_exp_f32 v48, v48
    v_exp_f32 v50, v50
    v_readfirstlane_b32 s19, v33
    v_mul_f32 v35, v36, v37
    v_fmac_f32 v35, v38, v39
    v_fmac_f32 v35, v40, v41
    v_fmac_f32 v35, v42, v43
    v_fmac_f32 v35, v44, v45
    v_fmac_f32 v35, v46, v47
    v_fmac_f32 v35, v48, v49
    v_fmac_f32 v35, v50, v51
    v_mov_b32 v55, v33
    v_max_f32 v22, 0x0da24260, v35
    v_log_f32 v35, v22
    v_rcp_f32 v22, v22
    v_mov_b32 v59, v33
    v_mov_b32 v63, v33
    v_add_f32 v62, v34, v35
    v_mul_f32 v36, v36, v22
    v_mul_f32 v38, v38, v22
    v_mul_f32 v40, v40, v22
    v_mul_f32 v42, v42, v22
    v_mul_f32 v44, v44, v22
    v_mul_f32 v46, v46, v22
    v_mul_f32 v48, v48, v22
    v_mul_f32 v50, v50, v22
    s_waitcnt lgkmcnt(0)
    v_pk_mul_f32 v[164:165], v[100:101], v[36:37] op_sel_hi:[1,0]
    v_pk_mul_f32 v[166:167], v[102:103], v[36:37] op_sel_hi:[1,0]
    v_pk_mul_f32 v[168:169], v[104:105], v[36:37] op_sel_hi:[1,0]
    v_pk_mul_f32 v[170:171], v[106:107], v[36:37] op_sel_hi:[1,0]
    v_pk_fma_f32 v[164:165], v[108:109], v[38:39], v[164:165] op_sel_hi:[1,0,1]
    v_pk_fma_f32 v[166:167], v[110:111], v[38:39], v[166:167] op_sel_hi:[1,0,1]
    v_pk_fma_f32 v[168:169], v[112:113], v[38:39], v[168:169] op_sel_hi:[1,0,1]
    v_pk_fma_f32 v[170:171], v[114:115], v[38:39], v[170:171] op_sel_hi:[1,0,1]
    v_pk_fma_f32 v[164:165], v[116:117], v[40:41], v[164:165] op_sel_hi:[1,0,1]
    v_pk_fma_f32 v[166:167], v[118:119], v[40:41], v[166:167] op_sel_hi:[1,0,1]
    v_pk_fma_f32 v[168:169], v[120:121], v[40:41], v[168:169] op_sel_hi:[1,0,1]
    v_pk_fma_f32 v[170:171], v[122:123], v[40:41], v[170:171] op_sel_hi:[1,0,1]
    v_pk_fma_f32 v[164:165], v[124:125], v[42:43], v[164:165] op_sel_hi:[1,0,1]
    v_pk_fma_f32 v[166:167], v[126:127], v[42:43], v[166:167] op_sel_hi:[1,0,1]
    v_pk_fma_f32 v[168:169], v[128:129], v[42:43], v[168:169] op_sel_hi:[1,0,1]
    v_pk_fma_f32 v[170:171], v[130:131], v[42:43], v[170:171] op_sel_hi:[1,0,1]
    v_pk_fma_f32 v[164:165], v[132:133], v[44:45], v[164:165] op_sel_hi:[1,0,1]
    v_pk_fma_f32 v[166:167], v[134:135], v[44:45], v[166:167] op_sel_hi:[1,0,1]
    v_pk_fma_f32 v[168:169], v[136:137], v[44:45], v[168:169] op_sel_hi:[1,0,1]
    v_pk_fma_f32 v[170:171], v[138:139], v[44:45], v[170:171] op_sel_hi:[1,0,1]
    v_pk_fma_f32 v[164:165], v[140:141], v[46:47], v[164:165] op_sel_hi:[1,0,1]
    v_pk_fma_f32 v[166:167], v[142:143], v[46:47], v[166:167] op_sel_hi:[1,0,1]
    v_pk_fma_f32 v[168:169], v[144:145], v[46:47], v[168:169] op_sel_hi:[1,0,1]
    v_pk_fma_f32 v[170:171], v[146:147], v[46:47], v[170:171] op_sel_hi:[1,0,1]
    v_pk_fma_f32 v[164:165], v[148:149], v[48:49], v[164:165] op_sel_hi:[1,0,1]
    v_pk_fma_f32 v[166:167], v[150:151], v[48:49], v[166:167] op_sel_hi:[1,0,1]
    v_pk_fma_f32 v[168:169], v[152:153], v[48:49], v[168:169] op_sel_hi:[1,0,1]
    v_pk_fma_f32 v[170:171], v[154:155], v[48:49], v[170:171] op_sel_hi:[1,0,1]
    v_fma_f32 v52, v156, v50, v164
    v_fma_f32 v53, v157, v50, v165
    v_fma_f32 v54, v158, v50, v166
    v_fma_f32 v56, v159, v50, v167
    v_fma_f32 v57, v160, v50, v168
    v_fma_f32 v58, v161, v50, v169
    v_fma_f32 v60, v162, v50, v170
    v_fma_f32 v61, v163, v50, v171
    buffer_store_dwordx4 v[52:55], v221, s[48:51], s32 offen offset:0 sc0 sc1
    buffer_store_dwordx4 v[56:59], v221, s[48:51], s32 offen offset:1024 sc0 sc1
    buffer_store_dwordx4 v[60:63], v221, s[48:51], s32 offen offset:2048 sc0 sc1
    s_cmp_lg_u32 s34, 0
    s_cbranch_scc1 L_multi
    s_waitcnt vmcnt(3)
L_havetk:
    v_readfirstlane_b32 s96, v212
    v_readfirstlane_b32 s97, v213
    v_mov_b32 v19, 1.0
    s_lshr_b64 s[96:97], s[96:97], s95
    s_and_b32 s79, s96, 0xff
    s_cmp_eq_u32 s79, s17
    s_cbranch_scc0 L_end
    s_cmp_eq_u32 s37, 0
    s_cbranch_scc1 L_final
L_gather:
    s_cmp_ge_u32 s37, 7
    s_cbranch_scc1 L_ga_t1_12
    s_cmp_ge_u32 s37, 4
    s_cbranch_scc1 L_ga_t1_6
    s_cmp_ge_u32 s37, 2
    s_cbranch_scc1 L_ga_t1_3
    s_branch L_ga_11
L_ga_t1_3:
    s_cmp_ge_u32 s37, 3
    s_cbranch_scc1 L_ga_9
    s_branch L_ga_10
L_ga_t1_6:
    s_cmp_ge_u32 s37, 5
    s_cbranch_scc1 L_ga_t4_6
    s_branch L_ga_8
L_ga_t4_6:
    s_cmp_ge_u32 s37, 6
    s_cbranch_scc1 L_ga_6
    s_branch L_ga_7
L_ga_t1_12:
    s_cmp_ge_u32 s37, 10
    s_cbranch_scc1 L_ga_t7_12
    s_cmp_ge_u32 s37, 8
    s_cbranch_scc1 L_ga_t7_9
    s_branch L_ga_5
L_ga_t7_9:
    s_cmp_ge_u32 s37, 9
    s_cbranch_scc1 L_ga_3
    s_branch L_ga_4
L_ga_t7_12:
    s_cmp_ge_u32 s37, 11
    s_cbranch_scc1 L_ga_t10_12
    s_branch L_ga_2
L_ga_t10_12:
    s_cmp_ge_u32 s37, 12
    s_cbranch_scc1 L_ga_0
    s_branch L_ga_1
L_ga_0:
    buffer_load_dwordx4 v[76:79], v221, s[48:51], s56 offen offset:2048 sc0 sc1
L_ga_1:
    buffer_load_dwordx4 v[88:91], v221, s[48:51], s57 offen offset:2048 sc0 sc1
L_ga_2:
    buffer_load_dwordx4 v[100:103], v221, s[48:51], s58 offen offset:2048 sc0 sc1
L_ga_3:
    buffer_load_dwordx4 v[112:115], v221, s[48:51], s59 offen offset:2048 sc0 sc1
L_ga_4:
    buffer_load_dwordx4 v[124:127], v221, s[48:51], s60 offen offset:2048 sc0 sc1
L_ga_5:
    buffer_load_dwordx4 v[136:139], v221, s[48:51], s61 offen offset:2048 sc0 sc1
L_ga_6:
    buffer_load_dwordx4 v[148:151], v221, s[48:51], s62 offen offset:2048 sc0 sc1
L_ga_7:
    buffer_load_dwordx4 v[160:163], v221, s[48:51], s63 offen offset:2048 sc0 sc1
L_ga_8:
    buffer_load_dwordx4 v[172:175], v221, s[48:51], s64 offen offset:2048 sc0 sc1
L_ga_9:
    buffer_load_dwordx4 v[184:187], v221, s[48:51], s65 offen offset:2048 sc0 sc1
L_ga_10:
    buffer_load_dwordx4 v[196:199], v221, s[48:51], s66 offen offset:2048 sc0 sc1
L_ga_11:
    buffer_load_dwordx4 v[208:211], v221, s[48:51], s67 offen offset:2048 sc0 sc1
    s_cmp_ge_u32 s37, 7
    s_cbranch_scc1 L_gb_t1_12
    s_cmp_ge_u32 s37, 4
    s_cbranch_scc1 L_gb_t1_6
    s_cmp_ge_u32 s37, 2
    s_cbranch_scc1 L_gb_t1_3
    s_branch L_gb_11
L_gb_t1_3:
    s_cmp_ge_u32 s37, 3
    s_cbranch_scc1 L_gb_9
    s_branch L_gb_10
L_gb_t1_6:
    s_cmp_ge_u32 s37, 5
    s_cbranch_scc1 L_gb_t4_6
    s_branch L_gb_8
L_gb_t4_6:
    s_cmp_ge_u32 s37, 6
    s_cbranch_scc1 L_gb_6
    s_branch L_gb_7
L_gb_t1_12:
    s_cmp_ge_u32 s37, 10
    s_cbranch_scc1 L_gb_t7_12
    s_cmp_ge_u32 s37, 8
    s_cbranch_scc1 L_gb_t7_9
    s_branch L_gb_5
L_gb_t7_9:
    s_cmp_ge_u32 s37, 9
    s_cbranch_scc1 L_gb_3
    s_branch L_gb_4
L_gb_t7_12:
    s_cmp_ge_u32 s37, 11
    s_cbranch_scc1 L_gb_t10_12
    s_branch L_gb_2
L_gb_t10_12:
    s_cmp_ge_u32 s37, 12
    s_cbranch_scc1 L_gb_0
    s_branch L_gb_1
L_gb_0:
    buffer_load_dwordx4 v[68:71], v221, s[48:51], s56 offen offset:0 sc0 sc1
    buffer_load_dwordx4 v[72:75], v221, s[48:51], s56 offen offset:1024 sc0 sc1
L_gb_1:
    buffer_load_dwordx4 v[80:83], v221, s[48:51], s57 offen offset:0 sc0 sc1
    buffer_load_dwordx4 v[84:87], v221, s[48:51], s57 offen offset:1024 sc0 sc1
L_gb_2:
    buffer_load_dwordx4 v[92:95], v221, s[48:51], s58 offen offset:0 sc0 sc1
    buffer_load_dwordx4 v[96:99], v221, s[48:51], s58 offen offset:1024 sc0 sc1
L_gb_3:
    buffer_load_dwordx4 v[104:107], v221, s[48:51], s59 offen offset:0 sc0 sc1
    buffer_load_dwordx4 v[108:111], v221, s[48:51], s59 offen offset:1024 sc0 sc1
L_gb_4:
    buffer_load_dwordx4 v[116:119], v221, s[48:51], s60 offen offset:0 sc0 sc1
    buffer_load_dwordx4 v[120:123], v221, s[48:51], s60 offen offset:1024 sc0 sc1
L_gb_5:
    buffer_load_dwordx4 v[128:131], v221, s[48:51], s61 offen offset:0 sc0 sc1
    buffer_load_dwordx4 v[132:135], v221, s[48:51], s61 offen offset:1024 sc0 sc1
L_gb_6:
    buffer_load_dwordx4 v[140:143], v221, s[48:51], s62 offen offset:0 sc0 sc1
    buffer_load_dwordx4 v[144:147], v221, s[48:51], s62 offen offset:1024 sc0 sc1
L_gb_7:
    buffer_load_dwordx4 v[152:155], v221, s[48:51], s63 offen offset:0 sc0 sc1
    buffer_load_dwordx4 v[156:159], v221, s[48:51], s63 offen offset:1024 sc0 sc1
L_gb_8:
    buffer_load_dwordx4 v[164:167], v221, s[48:51], s64 offen offset:0 sc0 sc1
    buffer_load_dwordx4 v[168:171], v221, s[48:51], s64 offen offset:1024 sc0 sc1
L_gb_9:
    buffer_load_dwordx4 v[176:179], v221, s[48:51], s65 offen offset:0 sc0 sc1
    buffer_load_dwordx4 v[180:183], v221, s[48:51], s65 offen offset:1024 sc0 sc1
L_gb_10:
    buffer_load_dwordx4 v[188:191], v221, s[48:51], s66 offen offset:0 sc0 sc1
    buffer_load_dwordx4 v[192:195], v221, s[48:51], s66 offen offset:1024 sc0 sc1
L_gb_11:
    buffer_load_dwordx4 v[200:203], v221, s[48:51], s67 offen offset:0 sc0 sc1
    buffer_load_dwordx4 v[204:207], v221, s[48:51], s67 offen offset:1024 sc0 sc1
L_gchk:
    v_mov_b32 v27, v62
    v_mov_b32 v21, s19
    v_mov_b32 v24, s19
    s_cmp_ge_u32 s37, 7
    s_cbranch_scc1 L_gc_t1_12
    s_cmp_ge_u32 s37, 4
    s_cbranch_scc1 L_gc_t1_6
    s_cmp_ge_u32 s37, 2
    s_cbranch_scc1 L_gc_t1_3
    s_branch L_gc_11
L_gc_t1_3:
    s_cmp_ge_u32 s37, 3
    s_cbranch_scc1 L_gc_9
    s_branch L_gc_10
L_gc_t1_6:
    s_cmp_ge_u32 s37, 5
    s_cbranch_scc1 L_gc_t4_6
    s_branch L_gc_8
L_gc_t4_6:
    s_cmp_ge_u32 s37, 6
    s_cbranch_scc1 L_gc_6
    s_branch L_gc_7
L_gc_t1_12:
    s_cmp_ge_u32 s37, 10
    s_cbranch_scc1 L_gc_t7_12
    s_cmp_ge_u32 s37, 8
    s_cbranch_scc1 L_gc_t7_9
    s_branch L_gc_5
L_gc_t7_9:
    s_cmp_ge_u32 s37, 9
    s_cbranch_scc1 L_gc_3
    s_branch L_gc_4
L_gc_t7_12:
    s_cmp_ge_u32 s37, 11
    s_cbranch_scc1 L_gc_t10_12
    s_branch L_gc_2
L_gc_t10_12:
    s_cmp_ge_u32 s37, 12
    s_cbranch_scc1 L_gc_0
    s_branch L_gc_1
L_gc_0:
    s_waitcnt vmcnt(24)
    s_branch L_gd_0
L_gc_1:
    s_waitcnt vmcnt(22)
    s_branch L_gd_1
L_gc_2:
    s_waitcnt vmcnt(20)
    s_branch L_gd_2
L_gc_3:
    s_waitcnt vmcnt(18)
    s_branch L_gd_3
L_gc_4:
    s_waitcnt vmcnt(16)
    s_branch L_gd_4
L_gc_5:
    s_waitcnt vmcnt(14)
    s_branch L_gd_5
L_gc_6:
    s_waitcnt vmcnt(12)
    s_branch L_gd_6
L_gc_7:
    s_waitcnt vmcnt(10)
    s_branch L_gd_7
L_gc_8:
    s_waitcnt vmcnt(8)
    s_branch L_gd_8
L_gc_9:
    s_waitcnt vmcnt(6)
    s_branch L_gd_9
L_gc_10:
    s_waitcnt vmcnt(4)
    s_branch L_gd_10
L_gc_11:
    s_waitcnt vmcnt(2)
    s_branch L_gd_11
L_gd_0:
    v_max_f32 v27, v27, v78
    v_min_u32 v21, v21, v79
    v_max_u32 v24, v24, v79
L_gd_1:
    v_max_f32 v27, v27, v90
    v_min_u32 v21, v21, v91
    v_max_u32 v24, v24, v91
L_gd_2:
    v_max_f32 v27, v27, v102
    v_min_u32 v21, v21, v103
    v_max_u32 v24, v24, v103
L_gd_3:
    v_max_f32 v27, v27, v114
    v_min_u32 v21, v21, v115
    v_max_u32 v24, v24, v115
L_gd_4:
    v_max_f32 v27, v27, v126
    v_min_u32 v21, v21, v127
    v_max_u32 v24, v24, v127
L_gd_5:
    v_max_f32 v27, v27, v138
    v_min_u32 v21, v21, v139
    v_max_u32 v24, v24, v139
L_gd_6:
    v_max_f32 v27, v27, v150
    v_min_u32 v21, v21, v151
    v_max_u32 v24, v24, v151
L_gd_7:
    v_max_f32 v27, v27, v162
    v_min_u32 v21, v21, v163
    v_max_u32 v24, v24, v163
L_gd_8:
    v_max_f32 v27, v27, v174
    v_min_u32 v21, v21, v175
    v_max_u32 v24, v24, v175
L_gd_9:
    v_max_f32 v27, v27, v186
    v_min_u32 v21, v21, v187
    v_max_u32 v24, v24, v187
L_gd_10:
    v_max_f32 v27, v27, v198
    v_min_u32 v21, v21, v199
    v_max_u32 v24, v24, v199
L_gd_11:
    v_max_f32 v27, v27, v210
    v_min_u32 v21, v21, v211
    v_max_u32 v24, v24, v211
    v_cmp_ne_u32 vcc, v21, v24
    v_sub_f32 v22, v62, v27
    v_exp_f32 v22, v22
    s_cbranch_vccnz L_retry
    v_mul_f32 v36, v22, v52
    v_mul_f32 v37, v22, v53
    v_mul_f32 v38, v22, v54
    v_mul_f32 v39, v22, v56
    v_mul_f32 v40, v22, v57
    v_mul_f32 v41, v22, v58
    v_mul_f32 v42, v22, v60
    v_mul_f32 v43, v22, v61
    v_mul_f32 v20, v22, v19
    s_cmp_ge_u32 s37, 7
    s_cbranch_scc1 L_ge_t1_12
    s_cmp_ge_u32 s37, 4
    s_cbranch_scc1 L_ge_t1_6
    s_cmp_ge_u32 s37, 2
    s_cbranch_scc1 L_ge_t1_3
    s_branch L_ge_11
L_ge_t1_3:
    s_cmp_ge_u32 s37, 3
    s_cbranch_scc1 L_ge_9
    s_branch L_ge_10
L_ge_t1_6:
    s_cmp_ge_u32 s37, 5
    s_cbranch_scc1 L_ge_t4_6
    s_branch L_ge_8
L_ge_t4_6:
    s_cmp_ge_u32 s37, 6
    s_cbranch_scc1 L_ge_6
    s_branch L_ge_7
L_ge_t1_12:
    s_cmp_ge_u32 s37, 10
    s_cbranch_scc1 L_ge_t7_12
    s_cmp_ge_u32 s37, 8
    s_cbranch_scc1 L_ge_t7_9
    s_branch L_ge_5
L_ge_t7_9:
    s_cmp_ge_u32 s37, 9
    s_cbranch_scc1 L_ge_3
    s_branch L_ge_4
L_ge_t7_12:
    s_cmp_ge_u32 s37, 11
    s_cbranch_scc1 L_ge_t10_12
    s_branch L_ge_2
L_ge_t10_12:
    s_cmp_ge_u32 s37, 12
    s_cbranch_scc1 L_ge_0
    s_branch L_ge_1
L_ge_0:
    v_sub_f32 v78, v78, v27
    v_exp_f32 v78, v78
    s_waitcnt vmcnt(22)
    v_min3_u32 v21, v21, v71, v75
    v_max3_u32 v24, v24, v71, v75
    v_add_f32 v20, v20, v78
    v_pk_fma_f32 v[36:37], v[68:69], v[78:79], v[36:37] op_sel_hi:[1,0,1]
    v_fmac_f32 v38, v78, v70
    v_fmac_f32 v39, v78, v72
    v_fmac_f32 v40, v78, v73
    v_fmac_f32 v41, v78, v74
    v_pk_fma_f32 v[42:43], v[76:77], v[78:79], v[42:43] op_sel_hi:[1,0,1]
L_ge_1:
    v_sub_f32 v90, v90, v27
    v_exp_f32 v90, v90
    s_waitcnt vmcnt(20)
    v_min3_u32 v21, v21, v83, v87
    v_max3_u32 v24, v24, v83, v87
    v_add_f32 v20, v20, v90
    v_pk_fma_f32 v[36:37], v[80:81], v[90:91], v[36:37] op_sel_hi:[1,0,1]
    v_fmac_f32 v38, v90, v82
    v_fmac_f32 v39, v90, v84
    v_fmac_f32 v40, v90, v85
    v_fmac_f32 v41, v90, v86
    v_pk_fma_f32 v[42:43], v[88:89], v[90:91], v[42:43] op_sel_hi:[1,0,1]
L_ge_2:
    v_sub_f32 v102, v102, v27
    v_exp_f32 v102, v102
    s_waitcnt vmcnt(18)
    v_min3_u32 v21, v21, v95, v99
    v_max3_u32 v24, v24, v95, v99
    v_add_f32 v20, v20, v102
    v_pk_fma_f32 v[36:37], v[92:93], v[102:103], v[36:37] op_sel_hi:[1,0,1]
    v_fmac_f32 v38, v102, v94
    v_fmac_f32 v39, v102, v96
    v_fmac_f32 v40, v102, v97
    v_fmac_f32 v41, v102, v98
    v_pk_fma_f32 v[42:43], v[100:101], v[102:103], v[42:43] op_sel_hi:[1,0,1]
L_ge_3:
    v_sub_f32 v114, v114, v27
    v_exp_f32 v114, v114
    s_waitcnt vmcnt(16)
    v_min3_u32 v21, v21, v107, v111
    v_max3_u32 v24, v24, v107, v111
    v_add_f32 v20, v20, v114
    v_pk_fma_f32 v[36:37], v[104:105], v[114:115], v[36:37] op_sel_hi:[1,0,1]
    v_fmac_f32 v38, v114, v106
    v_fmac_f32 v39, v114, v108
    v_fmac_f32 v40, v114, v109
    v_fmac_f32 v41, v114, v110
    v_pk_fma_f32 v[42:43], v[112:113], v[114:115], v[42:43] op_sel_hi:[1,0,1]
L_ge_4:
    v_sub_f32 v126, v126, v27
    v_exp_f32 v126, v126
    s_waitcnt vmcnt(14)
    v_min3_u32 v21, v21, v119, v123
    v_max3_u32 v24, v24, v119, v123
    v_add_f32 v20, v20, v126
    v_pk_fma_f32 v[36:37], v[116:117], v[126:127], v[36:37] op_sel_hi:[1,0,1]
    v_fmac_f32 v38, v126, v118
    v_fmac_f32 v39, v126, v120
    v_fmac_f32 v40, v126, v121
    v_fmac_f32 v41, v126, v122
    v_pk_fma_f32 v[42:43], v[124:125], v[126:127], v[42:43] op_sel_hi:[1,0,1]
L_ge_5:
    v_sub_f32 v138, v138, v27
    v_exp_f32 v138, v138
    s_waitcnt vmcnt(12)
    v_min3_u32 v21, v21, v131, v135
    v_max3_u32 v24, v24, v131, v135
    v_add_f32 v20, v20, v138
    v_pk_fma_f32 v[36:37], v[128:129], v[138:139], v[36:37] op_sel_hi:[1,0,1]
    v_fmac_f32 v38, v138, v130
    v_fmac_f32 v39, v138, v132
    v_fmac_f32 v40, v138, v133
    v_fmac_f32 v41, v138, v134
    v_pk_fma_f32 v[42:43], v[136:137], v[138:139], v[42:43] op_sel_hi:[1,0,1]
L_ge_6:
    v_sub_f32 v150, v150, v27
    v_exp_f32 v150, v150
    s_waitcnt vmcnt(10)
    v_min3_u32 v21, v21, v143, v147
    v_max3_u32 v24, v24, v143, v147
    v_add_f32 v20, v20, v150
    v_pk_fma_f32 v[36:37], v[140:141], v[150:151], v[36:37] op_sel_hi:[1,0,1]
    v_fmac_f32 v38, v150, v142
    v_fmac_f32 v39, v150, v144
    v_fmac_f32 v40, v150, v145
    v_fmac_f32 v41, v150, v146
    v_pk_fma_f32 v[42:43], v[148:149], v[150:151], v[42:43] op_sel_hi:[1,0,1]
L_ge_7:
    v_sub_f32 v162, v162, v27
    v_exp_f32 v162, v162
    s_waitcnt vmcnt(8)
    v_min3_u32 v21, v21, v155, v159
    v_max3_u32 v24, v24, v155, v159
    v_add_f32 v20, v20, v162
    v_pk_fma_f32 v[36:37], v[152:153], v[162:163], v[36:37] op_sel_hi:[1,0,1]
    v_fmac_f32 v38, v162, v154
    v_fmac_f32 v39, v162, v156
    v_fmac_f32 v40, v162, v157
    v_fmac_f32 v41, v162, v158
    v_pk_fma_f32 v[42:43], v[160:161], v[162:163], v[42:43] op_sel_hi:[1,0,1]
L_ge_8:
    v_sub_f32 v174, v174, v27
    v_exp_f32 v174, v174
    s_waitcnt vmcnt(6)
    v_min3_u32 v21, v21, v167, v171
    v_max3_u32 v24, v24, v167, v171
    v_add_f32 v20, v20, v174
    v_pk_fma_f32 v[36:37], v[164:165], v[174:175], v[36:37] op_sel_hi:[1,0,1]
    v_fmac_f32 v38, v174, v166
    v_fmac_f32 v39, v174, v168
    v_fmac_f32 v40, v174, v169
    v_fmac_f32 v41, v174, v170
    v_pk_fma_f32 v[42:43], v[172:173], v[174:175], v[42:43] op_sel_hi:[1,0,1]
L_ge_9:
    v_sub_f32 v186, v186, v27
    v_exp_f32 v186, v186
    s_waitcnt vmcnt(4)
    v_min3_u32 v21, v21, v179, v183
    v_max3_u32 v24, v24, v179, v183
    v_add_f32 v20, v20, v186
    v_pk_fma_f32 v[36:37], v[176:177], v[186:187], v[36:37] op_sel_hi:[1,0,1]
    v_fmac_f32 v38, v186, v178
    v_fmac_f32 v39, v186, v180
    v_fmac_f32 v40, v186, v181
    v_fmac_f32 v41, v186, v182
    v_pk_fma_f32 v[42:43], v[184:185], v[186:187], v[42:43] op_sel_hi:[1,0,1]
L_ge_10:
    v_sub_f32 v198, v198, v27
    v_exp_f32 v198, v198
    s_waitcnt vmcnt(2)
    v_min3_u32 v21, v21, v191, v195
    v_max3_u32 v24, v24, v191, v195
    v_add_f32 v20, v20, v198
    v_pk_fma_f32 v[36:37], v[188:189], v[198:199], v[36:37] op_sel_hi:[1,0,1]
    v_fmac_f32 v38, v198, v190
    v_fmac_f32 v39, v198, v192
    v_fmac_f32 v40, v198, v193
    v_fmac_f32 v41, v198, v194
    v_pk_fma_f32 v[42:43], v[196:197], v[198:199], v[42:43] op_sel_hi:[1,0,1]
L_ge_11:
    v_sub_f32 v210, v210, v27
    v_exp_f32 v210, v210
    s_waitcnt vmcnt(0)
    v_min3_u32 v21, v21, v203, v207
    v_max3_u32 v24, v24, v203, v207
    v_add_f32 v20, v20, v210
    v_pk_fma_f32 v[36:37], v[200:201], v[210:211], v[36:37] op_sel_hi:[1,0,1]
    v_fmac_f32 v38, v210, v202
    v_fmac_f32 v39, v210, v204
    v_fmac_f32 v40, v210, v205
    v_fmac_f32 v41, v210, v206
    v_pk_fma_f32 v[42:43], v[208:209], v[210:211], v[42:43] op_sel_hi:[1,0,1]
    v_cmp_ne_u32 vcc, v21, v24
    v_rcp_f32 v22, v20
    s_cmp_lg_u64 s[92:93], 0
    s_cbranch_vccnz L_retry
    s_cbranch_scc1 L_gather2
L_fin2:
    v_pk_mul_f32 v[36:37], v[36:37], v[22:23] op_sel_hi:[1,0]
    v_pk_mul_f32 v[38:39], v[38:39], v[22:23] op_sel_hi:[1,0]
    v_pk_mul_f32 v[40:41], v[40:41], v[22:23] op_sel_hi:[1,0]
    v_pk_mul_f32 v[42:43], v[42:43], v[22:23] op_sel_hi:[1,0]
    v_cvt_pk_bf16_f32 v36, v36, v40
    v_cvt_pk_bf16_f32 v37, v37, v41
    v_cvt_pk_bf16_f32 v38, v38, v42
    v_cvt_pk_bf16_f32 v39, v39, v43
    s_mov_b32 vcc_lo, 0x55555555
    s_mov_b32 vcc_hi, 0x55555555
    v_cndmask_b32_dpp v40, v37, v36, vcc quad_perm:[1,0,3,2] row_mask:0xf bank_mask:0xf
    v_cndmask_b32_dpp v42, v39, v38, vcc quad_perm:[1,0,3,2] row_mask:0xf bank_mask:0xf
    s_not_b64 vcc, vcc
    v_cndmask_b32_dpp v41, v36, v37, vcc quad_perm:[1,0,3,2] row_mask:0xf bank_mask:0xf
    v_cndmask_b32_dpp v43, v38, v39, vcc quad_perm:[1,0,3,2] row_mask:0xf bank_mask:0xf
    s_mov_b32 vcc_lo, 0x33333333
    s_mov_b32 vcc_hi, 0x33333333
    v_cndmask_b32_dpp v44, v42, v40, vcc quad_perm:[2,3,0,1] row_mask:0xf bank_mask:0xf
    v_cndmask_b32_dpp v45, v43, v41, vcc quad_perm:[2,3,0,1] row_mask:0xf bank_mask:0xf
    s_not_b64 vcc, vcc
    v_cndmask_b32_dpp v46, v40, v42, vcc quad_perm:[2,3,0,1] row_mask:0xf bank_mask:0xf
    v_cndmask_b32_dpp v47, v41, v43, vcc quad_perm:[2,3,0,1] row_mask:0xf bank_mask:0xf
    buffer_store_dwordx4 v[44:47], v221, s[52:55], s33 offen
L_end:
L_end2:
    s_endpgm
L_retry:
    s_add_u32 s6, s6, 1
    s_cmp_lt_u32 s6, 0x200000
    s_cbranch_scc1 L_gather
    s_branch L_end
L_nonget:
    s_load_dword s79, s[28:29], 128
    s_waitcnt lgkmcnt(0)
    s_cmp_lg_u32 s79, 0
    s_cbranch_scc1 L_nonput
    s_memrealtime s[96:97]
    v_mov_b32 v29, 0
    v_mov_b32 v26, 128
    s_waitcnt lgkmcnt(0)
    s_or_b32 s18, s96, 1
    v_mov_b32 v28, s18
    s_mov_b64 exec, 1
    global_atomic_cmpswap v0, v26, v[28:29], s[28:29] sc0 sc1
    s_mov_b64 exec, -1
    s_waitcnt vmcnt(0)
    v_readfirstlane_b32 s79, v0
    s_cmp_eq_u32 s79, 0
    s_cselect_b32 s79, s18, s79
L_nonput:
    v_mov_b32 v21, s79
    ds_write_b32 v222, v21
    s_branch L_nonon2
L_publish:
    s_cmp_lg_u32 s34, 0
    s_cbranch_scc1 L_end
    buffer_store_dwordx4 v[52:55], v221, s[48:51], s32 offen offset:0 sc0 sc1
    buffer_store_dwordx4 v[56:59], v221, s[48:51], s32 offen offset:1024 sc0 sc1
    buffer_store_dwordx4 v[60:63], v221, s[48:51], s32 offen offset:2048 sc0 sc1
    s_branch L_end
L_final:
    v_mov_b32 v36, v52
    v_mov_b32 v37, v53
    v_mov_b32 v38, v54
    v_mov_b32 v39, v56
    v_mov_b32 v40, v57
    v_mov_b32 v41, v58
    v_mov_b32 v42, v60
    v_mov_b32 v43, v61
    v_mov_b32 v22, 1.0
    s_branch L_fin2
L_multi:
    v_mov_b32 v32, 161832
    s_cmp_lg_u32 s3, 0
    s_cbranch_scc1 L_multi2
    s_waitcnt vmcnt(3)
    s_mov_b64 exec, 1
    ds_write_b64 v32, v[212:213]
    s_mov_b64 exec, -1
    s_waitcnt lgkmcnt(0)
L_multi2:
    s_barrier
    ds_read_b64 v[212:213], v32
    s_waitcnt lgkmcnt(0)
    s_branch L_havetk
L_gather2:
    v_mov_b32 v52, v36
    v_mov_b32 v53, v37
    v_mov_b32 v54, v38
    v_mov_b32 v56, v39
    v_mov_b32 v57, v40
    v_mov_b32 v58, v41
    v_mov_b32 v60, v42
    v_mov_b32 v61, v43
    v_mov_b32 v62, v27
    v_mov_b32 v19, v20
    s_bcnt1_i32_b64 s37, s[92:93]
    s_min_u32 s37, s37, 12
    s_ff1_i32_b64 s79, s[92:93]
    s_bitset0_b64 s[92:93], s79
    s_lshl_b32 s79, s79, 15
    s_add_u32 s67, s79, s94
    s_ff1_i32_b64 s79, s[92:93]
    s_bitset0_b64 s[92:93], s79
    s_lshl_b32 s79, s79, 15
    s_add_u32 s66, s79, s94
    s_ff1_i32_b64 s79, s[92:93]
    s_bitset0_b64 s[92:93], s79
    s_lshl_b32 s79, s79, 15
    s_add_u32 s65, s79, s94
    s_ff1_i32_b64 s79, s[92:93]
    s_bitset0_b64 s[92:93], s79
    s_lshl_b32 s79, s79, 15
    s_add_u32 s64, s79, s94
    s_ff1_i32_b64 s79, s[92:93]
    s_bitset0_b64 s[92:93], s79
    s_lshl_b32 s79, s79, 15
    s_add_u32 s63, s79, s94
    s_ff1_i32_b64 s79, s[92:93]
    s_bitset0_b64 s[92:93], s79
    s_lshl_b32 s79, s79, 15
    s_add_u32 s62, s79, s94
    s_ff1_i32_b64 s79, s[92:93]
    s_bitset0_b64 s[92:93], s79
    s_lshl_b32 s79, s79, 15
    s_add_u32 s61, s79, s94
    s_ff1_i32_b64 s79, s[92:93]
    s_bitset0_b64 s[92:93], s79
    s_lshl_b32 s79, s79, 15
    s_add_u32 s60, s79, s94
    s_ff1_i32_b64 s79, s[92:93]
    s_bitset0_b64 s[92:93], s79
    s_lshl_b32 s79, s79, 15
    s_add_u32 s59, s79, s94
    s_ff1_i32_b64 s79, s[92:93]
    s_bitset0_b64 s[92:93], s79
    s_lshl_b32 s79, s79, 15
    s_add_u32 s58, s79, s94
    s_ff1_i32_b64 s79, s[92:93]
    s_bitset0_b64 s[92:93], s79
    s_lshl_b32 s79, s79, 15
    s_add_u32 s57, s79, s94
    s_ff1_i32_b64 s79, s[92:93]
    s_bitset0_b64 s[92:93], s79
    s_lshl_b32 s79, s79, 15
    s_add_u32 s56, s79, s94
    s_branch L_gather
L_mispec:
    s_waitcnt vmcnt(0)
    s_add_u32 m0, s15, 0
    s_nop 0
    buffer_load_dwordx4 v2, s[40:43], s88 offen offset:0 nt lds
    buffer_load_dwordx4 v3, s[40:43], s88 offen offset:1024 nt lds
    buffer_load_dwordx4 v4, s[40:43], s88 offen offset:2048 nt lds
    buffer_load_dwordx4 v5, s[40:43], s88 offen offset:3072 nt lds
    buffer_load_dwordx4 v[164:167], v6, s[44:47], s88 offen offset:0 nt
    buffer_load_dwordx4 v[168:171], v6, s[44:47], s88 offen offset:2048 nt
    buffer_load_dwordx4 v[172:175], v7, s[44:47], s88 offen offset:0 nt
    buffer_load_dwordx4 v[176:179], v7, s[44:47], s88 offen offset:2048 nt
    s_branch L_specok
L_zq:
    s_bitcmp1_b32 s16, 0
    s_cbranch_scc0 L_zq0
    s_lshl_b64 exec, s[82:83], 0
    v_mov_b32 v68, 0
    v_mov_b32 v69, 0
    v_mov_b32 v70, 0
    v_mov_b32 v71, 0
    v_mov_b32 v72, 0
    v_mov_b32 v73, 0
    v_mov_b32 v74, 0
    v_mov_b32 v75, 0
    v_mov_b32 v76, 0
    v_mov_b32 v77, 0
    v_mov_b32 v78, 0
    v_mov_b32 v79, 0
    v_mov_b32 v80, 0
    v_mov_b32 v81, 0
    v_mov_b32 v82, 0
    v_mov_b32 v83, 0
L_zq0:
    s_bitcmp1_b32 s16, 1
    s_cbranch_scc0 L_zq1
    s_lshl_b64 exec, s[82:83], 4
    v_mov_b32 v68, 0
    v_mov_b32 v69, 0
    v_mov_b32 v70, 0
    v_mov_b32 v71, 0
    v_mov_b32 v72, 0
    v_mov_b32 v73, 0
    v_mov_b32 v74, 0
    v_mov_b32 v75, 0
    v_mov_b32 v76, 0
    v_mov_b32 v77, 0
    v_mov_b32 v78, 0
    v_mov_b32 v79, 0
    v_mov_b32 v80, 0
    v_mov_b32 v81, 0
    v_mov_b32 v82, 0
    v_mov_b32 v83, 0
L_zq1:
    s_bitcmp1_b32 s16, 2
    s_cbranch_scc0 L_zq2
    s_lshl_b64 exec, s[82:83], 8
    v_mov_b32 v68, 0
    v_mov_b32 v69, 0
    v_mov_b32 v70, 0
    v_mov_b32 v71, 0
    v_mov_b32 v72, 0
    v_mov_b32 v73, 0
    v_mov_b32 v74, 0
    v_mov_b32 v75, 0
    v_mov_b32 v76, 0
    v_mov_b32 v77, 0
    v_mov_b32 v78, 0
    v_mov_b32 v79, 0
    v_mov_b32 v80, 0
    v_mov_b32 v81, 0
    v_mov_b32 v82, 0
    v_mov_b32 v83, 0
L_zq2:
    s_bitcmp1_b32 s16, 3
    s_cbranch_scc0 L_zq3
    s_lshl_b64 exec, s[82:83], 12
    v_mov_b32 v68, 0
    v_mov_b32 v69, 0
    v_mov_b32 v70, 0
    v_mov_b32 v71, 0
    v_mov_b32 v72, 0
    v_mov_b32 v73, 0
    v_mov_b32 v74, 0
    v_mov_b32 v75, 0
    v_mov_b32 v76, 0
    v_mov_b32 v77, 0
    v_mov_b32 v78, 0
    v_mov_b32 v79, 0
    v_mov_b32 v80, 0
    v_mov_b32 v81, 0
    v_mov_b32 v82, 0
    v_mov_b32 v83, 0
L_zq3:
    s_bitcmp1_b32 s16, 4
    s_cbranch_scc0 L_zq4
    s_lshl_b64 exec, s[82:83], 0
    v_mov_b32 v84, 0
    v_mov_b32 v85, 0
    v_mov_b32 v86, 0
    v_mov_b32 v87, 0
    v_mov_b32 v88, 0
    v_mov_b32 v89, 0
    v_mov_b32 v90, 0
    v_mov_b32 v91, 0
    v_mov_b32 v92, 0
    v_mov_b32 v93, 0
    v_mov_b32 v94, 0
    v_mov_b32 v95, 0
    v_mov_b32 v96, 0
    v_mov_b32 v97, 0
    v_mov_b32 v98, 0
    v_mov_b32 v99, 0
L_zq4:
    s_bitcmp1_b32 s16, 5
    s_cbranch_scc0 L_zq5
    s_lshl_b64 exec, s[82:83], 4
    v_mov_b32 v84, 0
    v_mov_b32 v85, 0
    v_mov_b32 v86, 0
    v_mov_b32 v87, 0
    v_mov_b32 v88, 0
    v_mov_b32 v89, 0
    v_mov_b32 v90, 0
    v_mov_b32 v91, 0
    v_mov_b32 v92, 0
    v_mov_b32 v93, 0
    v_mov_b32 v94, 0
    v_mov_b32 v95, 0
    v_mov_b32 v96, 0
    v_mov_b32 v97, 0
    v_mov_b32 v98, 0
    v_mov_b32 v99, 0
L_zq5:
    s_bitcmp1_b32 s16, 6
    s_cbranch_scc0 L_zq6
    s_lshl_b64 exec, s[82:83], 8
    v_mov_b32 v84, 0
    v_mov_b32 v85, 0
    v_mov_b32 v86, 0
    v_mov_b32 v87, 0
    v_mov_b32 v88, 0
    v_mov_b32 v89, 0
    v_mov_b32 v90, 0
    v_mov_b32 v91, 0
    v_mov_b32 v92, 0
    v_mov_b32 v93, 0
    v_mov_b32 v94, 0
    v_mov_b32 v95, 0
    v_mov_b32 v96, 0
    v_mov_b32 v97, 0
    v_mov_b32 v98, 0
    v_mov_b32 v99, 0
L_zq6:
    s_bitcmp1_b32 s16, 7
    s_cbranch_scc0 L_zq7
    s_lshl_b64 exec, s[82:83], 12
    v_mov_b32 v84, 0
    v_mov_b32 v85, 0
    v_mov_b32 v86, 0
    v_mov_b32 v87, 0
    v_mov_b32 v88, 0
    v_mov_b32 v89, 0
    v_mov_b32 v90, 0
    v_mov_b32 v91, 0
    v_mov_b32 v92, 0
    v_mov_b32 v93, 0
    v_mov_b32 v94, 0
    v_mov_b32 v95, 0
    v_mov_b32 v96, 0
    v_mov_b32 v97, 0
    v_mov_b32 v98, 0
    v_mov_b32 v99, 0
L_zq7:
    s_mov_b64 exec, -1
    s_branch L_noz
.section .rodata,"a"
.p2align 6
.amdhsa_kernel standalone__paged_block_table_kv_radixattention__decode_kernel
  .amdhsa_next_free_vgpr 223
  .amdhsa_next_free_sgpr 102
  .amdhsa_accum_offset 224
  .amdhsa_group_segment_fixed_size 0
  .amdhsa_kernarg_size 64
  .amdhsa_user_sgpr_count 2
  .amdhsa_user_sgpr_kernarg_segment_ptr 1
  .amdhsa_system_sgpr_workgroup_id_x 1
.end_amdhsa_kernel
```
